```python
import torch

def _softmax(x, axis=-1):
    return torch.softmax(x, dim=axis)
def _gelu(x):
    return torch.nn.functional.gelu(x, approximate="tanh")
def _silu(x):
    return torch.nn.functional.silu(x)
def _sigmoid(x):
    return torch.sigmoid(x)
def _layernorm(x, axis=-1, eps=1e-5):
    m = x.mean(dim=axis, keepdim=True)
    v = x.var(dim=axis, keepdim=True, unbiased=False)
    return (x - m) / torch.sqrt(v + eps)
def _scatter_add(tgt, idx, src, axis=0):
    return tgt.clone().index_add_(axis, idx, src)
def _segment_sum(src, seg, n):
    out = torch.zeros((n,) + src.shape[1:], dtype=src.dtype)
    return out.index_add_(0, seg, src)
def _pad(x, pw):
    flat = tuple(v for pair in reversed(pw) for v in pair)
    return torch.nn.functional.pad(x, flat)

kernel_name = 'concat_heads__mha_block_cached__mha_block_cached__decode'

def setup_inputs():

    _w = (lambda a: (lambda t: t.to(torch.bfloat16) if t.is_floating_point() else t)(torch.as_tensor(a)))
    def _A_setup():
        B, Sq, D = 4, 1, 512
        H, Sk, Dh = 32, 4096, 128
        return {
            "x": _w((lambda *s: torch.randn(*s, dtype=torch.bfloat16) * 0.8)(B, Sq, D)),
            "k_cache": _w((lambda *s: torch.randn(*s, dtype=torch.bfloat16) * 1.6)(B, H, Sk, Dh)),
            "v_cache": _w((lambda *s: torch.randn(*s, dtype=torch.bfloat16) * 0.2)(B, H, Sk, Dh)),
            "wq": _w((lambda *s: torch.randn(*s, dtype=torch.bfloat16) * 1.6)(D, H * Dh) * (D ** -0.5)),
            "wo": _w((lambda *s: torch.randn(*s, dtype=torch.bfloat16) * 0.2)(H * Dh, D) * ((H * Dh) ** -0.5)),
        }
    _A_in = _A_setup()

    def _B_setup():
        B, Sq, D = 4, 1, 512
        H, Sk, Dh = 32, 4096, 128
        return {
            "x": _w((lambda *s: torch.randn(*s, dtype=torch.bfloat16) * 0.8)(B, Sq, D)),
            "k_cache": _w((lambda *s: torch.randn(*s, dtype=torch.bfloat16) * 1.6)(B, H, Sk, Dh)),
            "v_cache": _w((lambda *s: torch.randn(*s, dtype=torch.bfloat16) * 0.2)(B, H, Sk, Dh)),
            "wq": _w((lambda *s: torch.randn(*s, dtype=torch.bfloat16) * 1.6)(D, H * Dh) * (D ** -0.5)),
            "wo": _w((lambda *s: torch.randn(*s, dtype=torch.bfloat16) * 0.2)(H * Dh, D) * ((H * Dh) ** -0.5)),
        }
    _B_in = _B_setup()

    return {
        "A_x": _A_in["x"],
        "A_k_cache": _A_in["k_cache"],
        "A_v_cache": _A_in["v_cache"],
        "A_wq": _A_in["wq"],
        "A_wo": _A_in["wo"],
        "B_x": _B_in["x"],
        "B_k_cache": _B_in["k_cache"],
        "B_v_cache": _B_in["v_cache"],
        "B_wq": _B_in["wq"],
        "B_wo": _B_in["wo"],
    }

def reference(A_x, A_k_cache, A_v_cache, A_wq, A_wo, B_x, B_k_cache, B_v_cache, B_wq, B_wo):
    def _A_ref(x, k_cache, v_cache, wq, wo):
        B, Sq, D = x.shape
        H, Dh = 32, 128
        q = (lambda x, *d: x.permute(*d))((x @ wq).reshape(B, Sq, H, Dh), 0, 2, 1, 3)
        scores = torch.einsum("bhqd,bhkd->bhqk", q, k_cache) * (Dh ** -0.5)
        p = _softmax(scores, axis=-1)
        o = torch.einsum("bhqk,bhkd->bhqd", p, v_cache)
        return (lambda x, *d: x.permute(*d))(o, 0, 2, 1, 3).reshape(B, Sq, H * Dh) @ wo

    def _B_ref(x, k_cache, v_cache, wq, wo):
        B, Sq, D = x.shape
        H, Dh = 32, 128
        q = (lambda x, *d: x.permute(*d))((x @ wq).reshape(B, Sq, H, Dh), 0, 2, 1, 3)
        scores = torch.einsum("bhqd,bhkd->bhqk", q, k_cache) * (Dh ** -0.5)
        p = _softmax(scores, axis=-1)
        o = torch.einsum("bhqk,bhkd->bhqd", p, v_cache)
        return (lambda x, *d: x.permute(*d))(o, 0, 2, 1, 3).reshape(B, Sq, H * Dh) @ wo

    a = _A_ref(A_x, A_k_cache, A_v_cache, A_wq, A_wo)
    b = _B_ref(B_x, B_k_cache, B_v_cache, B_wq, B_wo)
    return torch.concatenate([a, b], axis=-1)
```

```asm
; @launch grid=(256,1,1) block=(512,1,1) lds=73728
.amdgcn_target "amdgcn-amd-amdhsa--gfx950"
.text
.globl concat_heads__mha_block_cached__mha_block_cached__decode_kernel
.p2align 8
.type concat_heads__mha_block_cached__mha_block_cached__decode_kernel,@function
concat_heads__mha_block_cached__mha_block_cached__decode_kernel:
s_cmp_ge_u32 s2, 256
s_cbranch_scc1 L_end
s_load_dwordx8 s[8:15], s[0:1], 0
s_load_dwordx2 s[16:17], s[0:1], 32
s_load_dwordx8 s[68:75], s[0:1], 40
s_load_dwordx2 s[76:77], s[0:1], 72
s_load_dwordx4 s[20:23], s[0:1], 80
s_load_dwordx2 s[24:25], s[0:1], 96
v_lshrrev_b32 v2, 6, v0
v_and_b32 v0, 63, v0
v_readfirstlane_b32 s18, v2
s_bfe_u32 s4, s2, 0x20003
s_bfe_u32 s6, s2, 0x10005
s_and_b32 s5, s2, 7
s_lshl_b32 s5, s5, 2
s_lshr_b32 s3, s2, 6
s_add_u32 s5, s5, s3
s_and_b32 s7, s18, 3
s_mov_b32 s19, 0
s_cmp_eq_u32 s18, 7
s_cbranch_scc0 L_noipf
s_getpc_b64 s[40:41]
L_pc:
v_lshlrev_b32 v3, 7, v0
v_cmp_gt_u32 vcc, L_end-L_pc, v3
s_mov_b64 exec, vcc
global_load_dword v250, v3, s[40:41]
v_add_u32 v3, 0x2000, v3
v_cmp_gt_u32 vcc, L_end-L_pc, v3
s_mov_b64 exec, vcc
s_cbranch_execz L_ipf2
global_load_dword v251, v3, s[40:41]
L_ipf2:
s_mov_b64 exec, -1
L_noipf:
s_cmp_ge_u32 s18, 4
s_cbranch_scc0 L_helper
s_lshl_b32 s63, s4, 5
s_add_u32 s63, s63, s5
s_bfe_u32 s3, s63, 0x50000
s_lshl_b32 s3, s3, 14
s_and_b32 s57, s3, 0x7fff
s_lshr_b32 s3, s3, 15
s_lshl_b32 s3, s3, 16
s_add_u32 s3, s3, s57
s_lshl_b32 s57, s7, 10
s_add_u32 s3, s3, s57
v_lshl_add_u32 v1, v0, 4, s3
s_lshl_b32 s63, s63, 20
s_mul_i32 s3, s6, 32768
s_add_u32 s63, s63, s3
s_movk_i32 s36, 0x1000
s_movk_i32 s37, 0x2000
s_movk_i32 s38, 0x3000
s_mov_b32 s30, 0xf8000
s_mov_b32 s31, 0x20000
s_waitcnt lgkmcnt(0)
s_add_u32 s28, s10, s63
s_addc_u32 s29, s11, 0
s_waitcnt vmcnt(4)
buffer_load_dwordx4 v[56:59], v1, s[28:31], 0 offen nt
s_waitcnt vmcnt(4)
buffer_load_dwordx4 v[60:63], v1, s[28:31], s36 offen nt
s_waitcnt vmcnt(4)
buffer_load_dwordx4 v[64:67], v1, s[28:31], s37 offen nt
s_waitcnt vmcnt(4)
buffer_load_dwordx4 v[68:71], v1, s[28:31], s38 offen nt
v_add_u32 v1, 0x4000, v1
v_and_b32 v3, 0x8000, v1
v_add_u32 v1, v3, v1
v_and_b32 v1, 0xfffff, v1
s_barrier
s_waitcnt vmcnt(4)
buffer_load_dwordx4 v[72:75], v1, s[28:31], 0 offen nt
s_waitcnt vmcnt(4)
buffer_load_dwordx4 v[76:79], v1, s[28:31], s36 offen nt
s_waitcnt vmcnt(4)
buffer_load_dwordx4 v[80:83], v1, s[28:31], s37 offen nt
s_waitcnt vmcnt(4)
buffer_load_dwordx4 v[84:87], v1, s[28:31], s38 offen nt
v_add_u32 v1, 0x4000, v1
v_and_b32 v3, 0x8000, v1
v_add_u32 v1, v3, v1
v_and_b32 v1, 0xfffff, v1
s_waitcnt vmcnt(4)
buffer_load_dwordx4 v[88:91], v1, s[28:31], 0 offen nt
s_waitcnt vmcnt(4)
buffer_load_dwordx4 v[92:95], v1, s[28:31], s36 offen nt
s_waitcnt vmcnt(4)
buffer_load_dwordx4 v[96:99], v1, s[28:31], s37 offen nt
s_waitcnt vmcnt(4)
buffer_load_dwordx4 v[100:103], v1, s[28:31], s38 offen nt
v_add_u32 v1, 0x4000, v1
v_and_b32 v3, 0x8000, v1
v_add_u32 v1, v3, v1
v_and_b32 v1, 0xfffff, v1
s_waitcnt vmcnt(4)
buffer_load_dwordx4 v[104:107], v1, s[28:31], 0 offen nt
s_waitcnt vmcnt(4)
buffer_load_dwordx4 v[108:111], v1, s[28:31], s36 offen nt
s_waitcnt vmcnt(4)
buffer_load_dwordx4 v[112:115], v1, s[28:31], s37 offen nt
s_waitcnt vmcnt(4)
buffer_load_dwordx4 v[116:119], v1, s[28:31], s38 offen nt
v_add_u32 v1, 0x4000, v1
v_and_b32 v3, 0x8000, v1
v_add_u32 v1, v3, v1
v_and_b32 v1, 0xfffff, v1
s_waitcnt vmcnt(4)
buffer_load_dwordx4 v[120:123], v1, s[28:31], 0 offen nt
s_waitcnt vmcnt(4)
buffer_load_dwordx4 v[124:127], v1, s[28:31], s36 offen nt
s_waitcnt vmcnt(4)
buffer_load_dwordx4 v[128:131], v1, s[28:31], s37 offen nt
s_waitcnt vmcnt(4)
buffer_load_dwordx4 v[132:135], v1, s[28:31], s38 offen nt
v_add_u32 v1, 0x4000, v1
v_and_b32 v3, 0x8000, v1
v_add_u32 v1, v3, v1
v_and_b32 v1, 0xfffff, v1
s_waitcnt vmcnt(4)
buffer_load_dwordx4 v[136:139], v1, s[28:31], 0 offen nt
s_waitcnt vmcnt(4)
buffer_load_dwordx4 v[140:143], v1, s[28:31], s36 offen nt
s_waitcnt vmcnt(4)
buffer_load_dwordx4 v[144:147], v1, s[28:31], s37 offen nt
s_waitcnt vmcnt(4)
buffer_load_dwordx4 v[148:151], v1, s[28:31], s38 offen nt
v_add_u32 v1, 0x4000, v1
v_and_b32 v3, 0x8000, v1
v_add_u32 v1, v3, v1
v_and_b32 v1, 0xfffff, v1
s_waitcnt vmcnt(4)
buffer_load_dwordx4 v[152:155], v1, s[28:31], 0 offen nt
s_waitcnt vmcnt(4)
buffer_load_dwordx4 v[156:159], v1, s[28:31], s36 offen nt
s_waitcnt vmcnt(4)
buffer_load_dwordx4 v[160:163], v1, s[28:31], s37 offen nt
s_waitcnt vmcnt(4)
buffer_load_dwordx4 v[164:167], v1, s[28:31], s38 offen nt
v_add_u32 v1, 0x4000, v1
v_and_b32 v3, 0x8000, v1
v_add_u32 v1, v3, v1
v_and_b32 v1, 0xfffff, v1
s_waitcnt vmcnt(4)
buffer_load_dwordx4 v[168:171], v1, s[28:31], 0 offen nt
s_waitcnt vmcnt(4)
buffer_load_dwordx4 v[172:175], v1, s[28:31], s36 offen nt
s_waitcnt vmcnt(4)
buffer_load_dwordx4 v[176:179], v1, s[28:31], s37 offen nt
s_waitcnt vmcnt(4)
buffer_load_dwordx4 v[180:183], v1, s[28:31], s38 offen nt
v_add_u32 v1, 0x4000, v1
v_and_b32 v3, 0x8000, v1
v_add_u32 v1, v3, v1
v_and_b32 v1, 0xfffff, v1
s_add_u32 s32, s12, s63
s_addc_u32 s33, s13, 0
s_add_u32 s34, s70, s63
s_addc_u32 s35, s71, 0
s_mov_b32 s62, s30
s_mov_b32 s58, 31
v_and_b32 v2, 1, v0
v_lshlrev_b32 v2, 4, v2
v_mov_b32 v3, 0xffff
v_lshlrev_b32 v2, v2, v3
v_bfe_u32 v3, v0, 1, 2
v_cmp_eq_u32 vcc, 0, v3
s_nop 1
v_cndmask_b32 v4, 0, v2, vcc
v_cmp_eq_u32 vcc, 1, v3
s_nop 1
v_cndmask_b32 v5, 0, v2, vcc
v_cmp_eq_u32 vcc, 2, v3
s_nop 1
v_cndmask_b32 v6, 0, v2, vcc
v_cmp_eq_u32 vcc, 3, v3
s_nop 1
v_cndmask_b32 v7, 0, v2, vcc
s_mov_b32 s40, 0x11111111
s_mov_b32 s41, 0x11111111
s_mov_b32 s42, 0x22222222
s_mov_b32 s43, 0x22222222
s_mov_b32 s44, 0x44444444
s_mov_b32 s45, 0x44444444
s_mov_b32 s46, 0x88888888
s_mov_b32 s47, 0x88888888
s_mov_b32 s60, 0x3fb8aa3b
s_mov_b32 s61, 0x3db504f3
v_and_b32 v184, 15, v0
s_lshl_b32 s3, s7, 9
v_lshrrev_b32 v3, 4, v0
v_lshlrev_b32 v19, 5, v184
v_lshl_add_u32 v19, v3, 4, v19
v_add_u32 v19, s3, v19
v_lshlrev_b32 v184, 4, v184
s_lshl_b32 s3, s7, 2
v_mov_b32 v185, s3
v_mov_b32 v186, 0
v_mov_b32 v187, 1
s_mov_b32 s59, 0
L_branch:
s_add_u32 s57, s19, 1
s_mov_b32 s56, 0x400000
L_qw:
ds_read_b128 v[12:15], v186 offset:6752
ds_read_b128 v[8:11], v184 offset:4096
s_sub_u32 s56, s56, 1
s_cbranch_scc1 L_end
s_waitcnt lgkmcnt(1)
v_min3_u32 v12, v12, v13, v14
v_min_u32 v12, v12, v15
s_nop 0
v_readfirstlane_b32 s3, v12
s_cmp_ge_u32 s3, s57
s_cbranch_scc0 L_qw
v_mov_b32 v20, 0xff800000
s_mov_b32 s56, 0
s_waitcnt lgkmcnt(0)
L_kloop:
s_cmp_eq_u32 s56, 24
s_cbranch_scc0 L_k1
s_mov_b32 s28, s32
s_mov_b32 s29, s33
L_k1:
v_mov_b32 v24, v26
v_mov_b32 v25, v27
v_mov_b32 v26, v28
v_mov_b32 v27, v29
v_mov_b32 v28, v30
v_mov_b32 v29, v31
s_mov_b64 exec, 1
ds_add_u32 v186, v187 offset:6768
ds_read_b64 v[188:189], v186 offset:6768
s_add_u32 s59, s59, 4
s_mov_b64 exec, -1
s_waitcnt vmcnt(28)
v_dot2_f32_bf16 v12, v56, v8, 0
v_dot2_f32_bf16 v13, v60, v8, 0
v_dot2_f32_bf16 v14, v64, v8, 0
v_dot2_f32_bf16 v15, v68, v8, 0
v_dot2_f32_bf16 v12, v57, v9, v12
v_dot2_f32_bf16 v13, v61, v9, v13
v_dot2_f32_bf16 v14, v65, v9, v14
v_dot2_f32_bf16 v15, v69, v9, v15
v_dot2_f32_bf16 v12, v58, v10, v12
v_dot2_f32_bf16 v13, v62, v10, v13
v_dot2_f32_bf16 v14, v66, v10, v14
v_dot2_f32_bf16 v15, v70, v10, v15
v_dot2_f32_bf16 v12, v59, v11, v12
v_dot2_f32_bf16 v13, v63, v11, v13
v_dot2_f32_bf16 v14, v67, v11, v14
v_dot2_f32_bf16 v15, v71, v11, v15
s_waitcnt lgkmcnt(0)
v_readfirstlane_b32 s3, v188
v_readfirstlane_b32 s39, v189
s_sub_i32 s3, s3, s59
s_cmp_ge_i32 s3, 1
s_cselect_b32 s3, 1, s39
s_cmp_eq_u32 s3, 1
s_cbranch_scc1 L_kd0_0
s_waitcnt vmcnt(4)
L_kd0_0:
s_waitcnt vmcnt(5)
buffer_load_dwordx4 v[56:59], v1, s[28:31], 0 offen nt
s_cbranch_scc1 L_kd0_1
s_waitcnt vmcnt(4)
L_kd0_1:
s_waitcnt vmcnt(5)
buffer_load_dwordx4 v[60:63], v1, s[28:31], s36 offen nt
s_cbranch_scc1 L_kd0_2
s_waitcnt vmcnt(4)
L_kd0_2:
s_waitcnt vmcnt(5)
buffer_load_dwordx4 v[64:67], v1, s[28:31], s37 offen nt
s_cbranch_scc1 L_kd0_3
s_waitcnt vmcnt(4)
L_kd0_3:
s_waitcnt vmcnt(5)
buffer_load_dwordx4 v[68:71], v1, s[28:31], s38 offen nt
v_add_u32 v1, 0x4000, v1
v_and_b32 v3, 0x8000, v1
v_add_u32 v1, v3, v1
v_and_b32 v1, 0xfffff, v1
v_add_f32_dpp v16, v12, v12 row_ror:8 row_mask:0xf bank_mask:0x3
v_add_f32_dpp v17, v14, v14 row_ror:8 row_mask:0xf bank_mask:0x3
v_add_f32_dpp v16, v13, v13 row_ror:8 row_mask:0xf bank_mask:0xc
v_add_f32_dpp v17, v15, v15 row_ror:8 row_mask:0xf bank_mask:0xc
s_nop 0
v_add_f32_dpp v18, v16, v16 row_half_mirror row_mask:0xf bank_mask:0x5
v_add_f32_dpp v18, v17, v17 row_half_mirror row_mask:0xf bank_mask:0xa
s_nop 1
v_add_f32_dpp v18, v18, v18 quad_perm:[1,0,3,2] row_mask:0xf bank_mask:0xf
s_nop 1
v_add_f32_dpp v18, v18, v18 quad_perm:[2,3,0,1] row_mask:0xf bank_mask:0xf
v_cndmask_b32 v22, v22, v18, s[40:41]
s_mov_b64 exec, 1
ds_add_u32 v186, v187 offset:6768
ds_read_b64 v[188:189], v186 offset:6768
s_add_u32 s59, s59, 4
s_mov_b64 exec, -1
s_waitcnt vmcnt(28)
v_dot2_f32_bf16 v12, v72, v8, 0
v_dot2_f32_bf16 v13, v76, v8, 0
v_dot2_f32_bf16 v14, v80, v8, 0
v_dot2_f32_bf16 v15, v84, v8, 0
v_dot2_f32_bf16 v12, v73, v9, v12
v_dot2_f32_bf16 v13, v77, v9, v13
v_dot2_f32_bf16 v14, v81, v9, v14
v_dot2_f32_bf16 v15, v85, v9, v15
v_dot2_f32_bf16 v12, v74, v10, v12
v_dot2_f32_bf16 v13, v78, v10, v13
v_dot2_f32_bf16 v14, v82, v10, v14
v_dot2_f32_bf16 v15, v86, v10, v15
v_dot2_f32_bf16 v12, v75, v11, v12
v_dot2_f32_bf16 v13, v79, v11, v13
v_dot2_f32_bf16 v14, v83, v11, v14
v_dot2_f32_bf16 v15, v87, v11, v15
s_waitcnt lgkmcnt(0)
v_readfirstlane_b32 s3, v188
v_readfirstlane_b32 s39, v189
s_sub_i32 s3, s3, s59
s_cmp_ge_i32 s3, 1
s_cselect_b32 s3, 1, s39
s_cmp_eq_u32 s3, 1
s_cbranch_scc1 L_kd1_0
s_waitcnt vmcnt(4)
L_kd1_0:
s_waitcnt vmcnt(5)
buffer_load_dwordx4 v[72:75], v1, s[28:31], 0 offen nt
s_cbranch_scc1 L_kd1_1
s_waitcnt vmcnt(4)
L_kd1_1:
s_waitcnt vmcnt(5)
buffer_load_dwordx4 v[76:79], v1, s[28:31], s36 offen nt
s_cbranch_scc1 L_kd1_2
s_waitcnt vmcnt(4)
L_kd1_2:
s_waitcnt vmcnt(5)
buffer_load_dwordx4 v[80:83], v1, s[28:31], s37 offen nt
s_cbranch_scc1 L_kd1_3
s_waitcnt vmcnt(4)
L_kd1_3:
s_waitcnt vmcnt(5)
buffer_load_dwordx4 v[84:87], v1, s[28:31], s38 offen nt
v_add_u32 v1, 0x4000, v1
v_and_b32 v3, 0x8000, v1
v_add_u32 v1, v3, v1
v_and_b32 v1, 0xfffff, v1
v_add_f32_dpp v16, v12, v12 row_ror:8 row_mask:0xf bank_mask:0x3
v_add_f32_dpp v17, v14, v14 row_ror:8 row_mask:0xf bank_mask:0x3
v_add_f32_dpp v16, v13, v13 row_ror:8 row_mask:0xf bank_mask:0xc
v_add_f32_dpp v17, v15, v15 row_ror:8 row_mask:0xf bank_mask:0xc
s_nop 0
v_add_f32_dpp v18, v16, v16 row_half_mirror row_mask:0xf bank_mask:0x5
v_add_f32_dpp v18, v17, v17 row_half_mirror row_mask:0xf bank_mask:0xa
s_nop 1
v_add_f32_dpp v18, v18, v18 quad_perm:[1,0,3,2] row_mask:0xf bank_mask:0xf
s_nop 1
v_add_f32_dpp v18, v18, v18 quad_perm:[2,3,0,1] row_mask:0xf bank_mask:0xf
v_cndmask_b32 v22, v22, v18, s[42:43]
s_mov_b64 exec, 1
ds_add_u32 v186, v187 offset:6768
ds_read_b64 v[188:189], v186 offset:6768
s_add_u32 s59, s59, 4
s_mov_b64 exec, -1
s_waitcnt vmcnt(28)
v_dot2_f32_bf16 v12, v88, v8, 0
v_dot2_f32_bf16 v13, v92, v8, 0
v_dot2_f32_bf16 v14, v96, v8, 0
v_dot2_f32_bf16 v15, v100, v8, 0
v_dot2_f32_bf16 v12, v89, v9, v12
v_dot2_f32_bf16 v13, v93, v9, v13
v_dot2_f32_bf16 v14, v97, v9, v14
v_dot2_f32_bf16 v15, v101, v9, v15
v_dot2_f32_bf16 v12, v90, v10, v12
v_dot2_f32_bf16 v13, v94, v10, v13
v_dot2_f32_bf16 v14, v98, v10, v14
v_dot2_f32_bf16 v15, v102, v10, v15
v_dot2_f32_bf16 v12, v91, v11, v12
v_dot2_f32_bf16 v13, v95, v11, v13
v_dot2_f32_bf16 v14, v99, v11, v14
v_dot2_f32_bf16 v15, v103, v11, v15
s_waitcnt lgkmcnt(0)
v_readfirstlane_b32 s3, v188
v_readfirstlane_b32 s39, v189
s_sub_i32 s3, s3, s59
s_cmp_ge_i32 s3, 1
s_cselect_b32 s3, 1, s39
s_cmp_eq_u32 s3, 1
s_cbranch_scc1 L_kd2_0
s_waitcnt vmcnt(4)
L_kd2_0:
s_waitcnt vmcnt(5)
buffer_load_dwordx4 v[88:91], v1, s[28:31], 0 offen nt
s_cbranch_scc1 L_kd2_1
s_waitcnt vmcnt(4)
L_kd2_1:
s_waitcnt vmcnt(5)
buffer_load_dwordx4 v[92:95], v1, s[28:31], s36 offen nt
s_cbranch_scc1 L_kd2_2
s_waitcnt vmcnt(4)
L_kd2_2:
s_waitcnt vmcnt(5)
buffer_load_dwordx4 v[96:99], v1, s[28:31], s37 offen nt
s_cbranch_scc1 L_kd2_3
s_waitcnt vmcnt(4)
L_kd2_3:
s_waitcnt vmcnt(5)
buffer_load_dwordx4 v[100:103], v1, s[28:31], s38 offen nt
v_add_u32 v1, 0x4000, v1
v_and_b32 v3, 0x8000, v1
v_add_u32 v1, v3, v1
v_and_b32 v1, 0xfffff, v1
v_add_f32_dpp v16, v12, v12 row_ror:8 row_mask:0xf bank_mask:0x3
v_add_f32_dpp v17, v14, v14 row_ror:8 row_mask:0xf bank_mask:0x3
v_add_f32_dpp v16, v13, v13 row_ror:8 row_mask:0xf bank_mask:0xc
v_add_f32_dpp v17, v15, v15 row_ror:8 row_mask:0xf bank_mask:0xc
s_nop 0
v_add_f32_dpp v18, v16, v16 row_half_mirror row_mask:0xf bank_mask:0x5
v_add_f32_dpp v18, v17, v17 row_half_mirror row_mask:0xf bank_mask:0xa
s_nop 1
v_add_f32_dpp v18, v18, v18 quad_perm:[1,0,3,2] row_mask:0xf bank_mask:0xf
s_nop 1
v_add_f32_dpp v18, v18, v18 quad_perm:[2,3,0,1] row_mask:0xf bank_mask:0xf
v_cndmask_b32 v22, v22, v18, s[44:45]
s_mov_b64 exec, 1
ds_add_u32 v186, v187 offset:6768
ds_read_b64 v[188:189], v186 offset:6768
s_add_u32 s59, s59, 4
s_mov_b64 exec, -1
s_waitcnt vmcnt(28)
v_dot2_f32_bf16 v12, v104, v8, 0
v_dot2_f32_bf16 v13, v108, v8, 0
v_dot2_f32_bf16 v14, v112, v8, 0
v_dot2_f32_bf16 v15, v116, v8, 0
v_dot2_f32_bf16 v12, v105, v9, v12
v_dot2_f32_bf16 v13, v109, v9, v13
v_dot2_f32_bf16 v14, v113, v9, v14
v_dot2_f32_bf16 v15, v117, v9, v15
v_dot2_f32_bf16 v12, v106, v10, v12
v_dot2_f32_bf16 v13, v110, v10, v13
v_dot2_f32_bf16 v14, v114, v10, v14
v_dot2_f32_bf16 v15, v118, v10, v15
v_dot2_f32_bf16 v12, v107, v11, v12
v_dot2_f32_bf16 v13, v111, v11, v13
v_dot2_f32_bf16 v14, v115, v11, v14
v_dot2_f32_bf16 v15, v119, v11, v15
s_waitcnt lgkmcnt(0)
v_readfirstlane_b32 s3, v188
v_readfirstlane_b32 s39, v189
s_sub_i32 s3, s3, s59
s_cmp_ge_i32 s3, 1
s_cselect_b32 s3, 1, s39
s_cmp_eq_u32 s3, 1
s_cbranch_scc1 L_kd3_0
s_waitcnt vmcnt(4)
L_kd3_0:
s_waitcnt vmcnt(5)
buffer_load_dwordx4 v[104:107], v1, s[28:31], 0 offen nt
s_cbranch_scc1 L_kd3_1
s_waitcnt vmcnt(4)
L_kd3_1:
s_waitcnt vmcnt(5)
buffer_load_dwordx4 v[108:111], v1, s[28:31], s36 offen nt
s_cbranch_scc1 L_kd3_2
s_waitcnt vmcnt(4)
L_kd3_2:
s_waitcnt vmcnt(5)
buffer_load_dwordx4 v[112:115], v1, s[28:31], s37 offen nt
s_cbranch_scc1 L_kd3_3
s_waitcnt vmcnt(4)
L_kd3_3:
s_waitcnt vmcnt(5)
buffer_load_dwordx4 v[116:119], v1, s[28:31], s38 offen nt
v_add_u32 v1, 0x4000, v1
v_and_b32 v3, 0x8000, v1
v_add_u32 v1, v3, v1
v_and_b32 v1, 0xfffff, v1
v_add_f32_dpp v16, v12, v12 row_ror:8 row_mask:0xf bank_mask:0x3
v_add_f32_dpp v17, v14, v14 row_ror:8 row_mask:0xf bank_mask:0x3
v_add_f32_dpp v16, v13, v13 row_ror:8 row_mask:0xf bank_mask:0xc
v_add_f32_dpp v17, v15, v15 row_ror:8 row_mask:0xf bank_mask:0xc
s_nop 0
v_add_f32_dpp v18, v16, v16 row_half_mirror row_mask:0xf bank_mask:0x5
v_add_f32_dpp v18, v17, v17 row_half_mirror row_mask:0xf bank_mask:0xa
s_nop 1
v_add_f32_dpp v18, v18, v18 quad_perm:[1,0,3,2] row_mask:0xf bank_mask:0xf
s_nop 1
v_add_f32_dpp v18, v18, v18 quad_perm:[2,3,0,1] row_mask:0xf bank_mask:0xf
v_cndmask_b32 v22, v22, v18, s[46:47]
v_cvt_pk_bf16_f32 v2, v22, v22
v_lshlrev_b32 v2, 16, v2
v_mul_f32 v2, s61, v2
v_cvt_pk_bf16_f32 v2, v2, v2
v_lshlrev_b32 v30, 16, v2
v_max_f32 v20, v20, v30
s_mov_b64 exec, 1
ds_add_u32 v186, v187 offset:6768
ds_read_b64 v[188:189], v186 offset:6768
s_add_u32 s59, s59, 4
s_mov_b64 exec, -1
s_waitcnt vmcnt(28)
v_dot2_f32_bf16 v12, v120, v8, 0
v_dot2_f32_bf16 v13, v124, v8, 0
v_dot2_f32_bf16 v14, v128, v8, 0
v_dot2_f32_bf16 v15, v132, v8, 0
v_dot2_f32_bf16 v12, v121, v9, v12
v_dot2_f32_bf16 v13, v125, v9, v13
v_dot2_f32_bf16 v14, v129, v9, v14
v_dot2_f32_bf16 v15, v133, v9, v15
v_dot2_f32_bf16 v12, v122, v10, v12
v_dot2_f32_bf16 v13, v126, v10, v13
v_dot2_f32_bf16 v14, v130, v10, v14
v_dot2_f32_bf16 v15, v134, v10, v15
v_dot2_f32_bf16 v12, v123, v11, v12
v_dot2_f32_bf16 v13, v127, v11, v13
v_dot2_f32_bf16 v14, v131, v11, v14
v_dot2_f32_bf16 v15, v135, v11, v15
s_waitcnt lgkmcnt(0)
v_readfirstlane_b32 s3, v188
v_readfirstlane_b32 s39, v189
s_sub_i32 s3, s3, s59
s_cmp_ge_i32 s3, 1
s_cselect_b32 s3, 1, s39
s_cmp_eq_u32 s3, 1
s_cbranch_scc1 L_kd4_0
s_waitcnt vmcnt(4)
L_kd4_0:
s_waitcnt vmcnt(5)
buffer_load_dwordx4 v[120:123], v1, s[28:31], 0 offen nt
s_cbranch_scc1 L_kd4_1
s_waitcnt vmcnt(4)
L_kd4_1:
s_waitcnt vmcnt(5)
buffer_load_dwordx4 v[124:127], v1, s[28:31], s36 offen nt
s_cbranch_scc1 L_kd4_2
s_waitcnt vmcnt(4)
L_kd4_2:
s_waitcnt vmcnt(5)
buffer_load_dwordx4 v[128:131], v1, s[28:31], s37 offen nt
s_cbranch_scc1 L_kd4_3
s_waitcnt vmcnt(4)
L_kd4_3:
s_waitcnt vmcnt(5)
buffer_load_dwordx4 v[132:135], v1, s[28:31], s38 offen nt
v_add_u32 v1, 0x4000, v1
v_and_b32 v3, 0x8000, v1
v_add_u32 v1, v3, v1
v_and_b32 v1, 0xfffff, v1
v_add_f32_dpp v16, v12, v12 row_ror:8 row_mask:0xf bank_mask:0x3
v_add_f32_dpp v17, v14, v14 row_ror:8 row_mask:0xf bank_mask:0x3
v_add_f32_dpp v16, v13, v13 row_ror:8 row_mask:0xf bank_mask:0xc
v_add_f32_dpp v17, v15, v15 row_ror:8 row_mask:0xf bank_mask:0xc
s_nop 0
v_add_f32_dpp v18, v16, v16 row_half_mirror row_mask:0xf bank_mask:0x5
v_add_f32_dpp v18, v17, v17 row_half_mirror row_mask:0xf bank_mask:0xa
s_nop 1
v_add_f32_dpp v18, v18, v18 quad_perm:[1,0,3,2] row_mask:0xf bank_mask:0xf
s_nop 1
v_add_f32_dpp v18, v18, v18 quad_perm:[2,3,0,1] row_mask:0xf bank_mask:0xf
v_cndmask_b32 v22, v22, v18, s[40:41]
s_mov_b64 exec, 1
ds_add_u32 v186, v187 offset:6768
ds_read_b64 v[188:189], v186 offset:6768
s_add_u32 s59, s59, 4
s_mov_b64 exec, -1
s_waitcnt vmcnt(28)
v_dot2_f32_bf16 v12, v136, v8, 0
v_dot2_f32_bf16 v13, v140, v8, 0
v_dot2_f32_bf16 v14, v144, v8, 0
v_dot2_f32_bf16 v15, v148, v8, 0
v_dot2_f32_bf16 v12, v137, v9, v12
v_dot2_f32_bf16 v13, v141, v9, v13
v_dot2_f32_bf16 v14, v145, v9, v14
v_dot2_f32_bf16 v15, v149, v9, v15
v_dot2_f32_bf16 v12, v138, v10, v12
v_dot2_f32_bf16 v13, v142, v10, v13
v_dot2_f32_bf16 v14, v146, v10, v14
v_dot2_f32_bf16 v15, v150, v10, v15
v_dot2_f32_bf16 v12, v139, v11, v12
v_dot2_f32_bf16 v13, v143, v11, v13
v_dot2_f32_bf16 v14, v147, v11, v14
v_dot2_f32_bf16 v15, v151, v11, v15
s_waitcnt lgkmcnt(0)
v_readfirstlane_b32 s3, v188
v_readfirstlane_b32 s39, v189
s_sub_i32 s3, s3, s59
s_cmp_ge_i32 s3, 1
s_cselect_b32 s3, 1, s39
s_cmp_eq_u32 s3, 1
s_cbranch_scc1 L_kd5_0
s_waitcnt vmcnt(4)
L_kd5_0:
s_waitcnt vmcnt(5)
buffer_load_dwordx4 v[136:139], v1, s[28:31], 0 offen nt
s_cbranch_scc1 L_kd5_1
s_waitcnt vmcnt(4)
L_kd5_1:
s_waitcnt vmcnt(5)
buffer_load_dwordx4 v[140:143], v1, s[28:31], s36 offen nt
s_cbranch_scc1 L_kd5_2
s_waitcnt vmcnt(4)
L_kd5_2:
s_waitcnt vmcnt(5)
buffer_load_dwordx4 v[144:147], v1, s[28:31], s37 offen nt
s_cbranch_scc1 L_kd5_3
s_waitcnt vmcnt(4)
L_kd5_3:
s_waitcnt vmcnt(5)
buffer_load_dwordx4 v[148:151], v1, s[28:31], s38 offen nt
v_add_u32 v1, 0x4000, v1
v_and_b32 v3, 0x8000, v1
v_add_u32 v1, v3, v1
v_and_b32 v1, 0xfffff, v1
v_add_f32_dpp v16, v12, v12 row_ror:8 row_mask:0xf bank_mask:0x3
v_add_f32_dpp v17, v14, v14 row_ror:8 row_mask:0xf bank_mask:0x3
v_add_f32_dpp v16, v13, v13 row_ror:8 row_mask:0xf bank_mask:0xc
v_add_f32_dpp v17, v15, v15 row_ror:8 row_mask:0xf bank_mask:0xc
s_nop 0
v_add_f32_dpp v18, v16, v16 row_half_mirror row_mask:0xf bank_mask:0x5
v_add_f32_dpp v18, v17, v17 row_half_mirror row_mask:0xf bank_mask:0xa
s_nop 1
v_add_f32_dpp v18, v18, v18 quad_perm:[1,0,3,2] row_mask:0xf bank_mask:0xf
s_nop 1
v_add_f32_dpp v18, v18, v18 quad_perm:[2,3,0,1] row_mask:0xf bank_mask:0xf
v_cndmask_b32 v22, v22, v18, s[42:43]
s_mov_b64 exec, 1
ds_add_u32 v186, v187 offset:6768
ds_read_b64 v[188:189], v186 offset:6768
s_add_u32 s59, s59, 4
s_mov_b64 exec, -1
s_waitcnt vmcnt(28)
v_dot2_f32_bf16 v12, v152, v8, 0
v_dot2_f32_bf16 v13, v156, v8, 0
v_dot2_f32_bf16 v14, v160, v8, 0
v_dot2_f32_bf16 v15, v164, v8, 0
v_dot2_f32_bf16 v12, v153, v9, v12
v_dot2_f32_bf16 v13, v157, v9, v13
v_dot2_f32_bf16 v14, v161, v9, v14
v_dot2_f32_bf16 v15, v165, v9, v15
v_dot2_f32_bf16 v12, v154, v10, v12
v_dot2_f32_bf16 v13, v158, v10, v13
v_dot2_f32_bf16 v14, v162, v10, v14
v_dot2_f32_bf16 v15, v166, v10, v15
v_dot2_f32_bf16 v12, v155, v11, v12
v_dot2_f32_bf16 v13, v159, v11, v13
v_dot2_f32_bf16 v14, v163, v11, v14
v_dot2_f32_bf16 v15, v167, v11, v15
s_waitcnt lgkmcnt(0)
v_readfirstlane_b32 s3, v188
v_readfirstlane_b32 s39, v189
s_sub_i32 s3, s3, s59
s_cmp_ge_i32 s3, 1
s_cselect_b32 s3, 1, s39
s_cmp_eq_u32 s3, 1
s_cbranch_scc1 L_kd6_0
s_waitcnt vmcnt(4)
L_kd6_0:
s_waitcnt vmcnt(5)
buffer_load_dwordx4 v[152:155], v1, s[28:31], 0 offen nt
s_cbranch_scc1 L_kd6_1
s_waitcnt vmcnt(4)
L_kd6_1:
s_waitcnt vmcnt(5)
buffer_load_dwordx4 v[156:159], v1, s[28:31], s36 offen nt
s_cbranch_scc1 L_kd6_2
s_waitcnt vmcnt(4)
L_kd6_2:
s_waitcnt vmcnt(5)
buffer_load_dwordx4 v[160:163], v1, s[28:31], s37 offen nt
s_cbranch_scc1 L_kd6_3
s_waitcnt vmcnt(4)
L_kd6_3:
s_waitcnt vmcnt(5)
buffer_load_dwordx4 v[164:167], v1, s[28:31], s38 offen nt
v_add_u32 v1, 0x4000, v1
v_and_b32 v3, 0x8000, v1
v_add_u32 v1, v3, v1
v_and_b32 v1, 0xfffff, v1
v_add_f32_dpp v16, v12, v12 row_ror:8 row_mask:0xf bank_mask:0x3
v_add_f32_dpp v17, v14, v14 row_ror:8 row_mask:0xf bank_mask:0x3
v_add_f32_dpp v16, v13, v13 row_ror:8 row_mask:0xf bank_mask:0xc
v_add_f32_dpp v17, v15, v15 row_ror:8 row_mask:0xf bank_mask:0xc
s_nop 0
v_add_f32_dpp v18, v16, v16 row_half_mirror row_mask:0xf bank_mask:0x5
v_add_f32_dpp v18, v17, v17 row_half_mirror row_mask:0xf bank_mask:0xa
s_nop 1
v_add_f32_dpp v18, v18, v18 quad_perm:[1,0,3,2] row_mask:0xf bank_mask:0xf
s_nop 1
v_add_f32_dpp v18, v18, v18 quad_perm:[2,3,0,1] row_mask:0xf bank_mask:0xf
v_cndmask_b32 v22, v22, v18, s[44:45]
s_mov_b64 exec, 1
ds_add_u32 v186, v187 offset:6768
ds_read_b64 v[188:189], v186 offset:6768
s_add_u32 s59, s59, 4
s_mov_b64 exec, -1
s_waitcnt vmcnt(28)
v_dot2_f32_bf16 v12, v168, v8, 0
v_dot2_f32_bf16 v13, v172, v8, 0
v_dot2_f32_bf16 v14, v176, v8, 0
v_dot2_f32_bf16 v15, v180, v8, 0
v_dot2_f32_bf16 v12, v169, v9, v12
v_dot2_f32_bf16 v13, v173, v9, v13
v_dot2_f32_bf16 v14, v177, v9, v14
v_dot2_f32_bf16 v15, v181, v9, v15
v_dot2_f32_bf16 v12, v170, v10, v12
v_dot2_f32_bf16 v13, v174, v10, v13
v_dot2_f32_bf16 v14, v178, v10, v14
v_dot2_f32_bf16 v15, v182, v10, v15
v_dot2_f32_bf16 v12, v171, v11, v12
v_dot2_f32_bf16 v13, v175, v11, v13
v_dot2_f32_bf16 v14, v179, v11, v14
v_dot2_f32_bf16 v15, v183, v11, v15
s_cmp_eq_u32 s56, 24
s_cbranch_scc1 L_kb7
s_waitcnt lgkmcnt(0)
v_readfirstlane_b32 s3, v188
v_readfirstlane_b32 s39, v189
s_sub_i32 s3, s3, s59
s_cmp_ge_i32 s3, 1
s_cselect_b32 s3, 1, s39
s_cmp_eq_u32 s3, 1
s_cbranch_scc1 L_kd7_0
s_waitcnt vmcnt(4)
L_kd7_0:
s_waitcnt vmcnt(5)
buffer_load_dwordx4 v[168:171], v1, s[28:31], 0 offen nt
s_cbranch_scc1 L_kd7_1
s_waitcnt vmcnt(4)
L_kd7_1:
s_waitcnt vmcnt(5)
buffer_load_dwordx4 v[172:175], v1, s[28:31], s36 offen nt
s_cbranch_scc1 L_kd7_2
s_waitcnt vmcnt(4)
L_kd7_2:
s_waitcnt vmcnt(5)
buffer_load_dwordx4 v[176:179], v1, s[28:31], s37 offen nt
s_cbranch_scc1 L_kd7_3
s_waitcnt vmcnt(4)
L_kd7_3:
s_waitcnt vmcnt(5)
buffer_load_dwordx4 v[180:183], v1, s[28:31], s38 offen nt
v_add_u32 v1, 0x4000, v1
v_and_b32 v3, 0x8000, v1
v_add_u32 v1, v3, v1
v_and_b32 v1, 0xfffff, v1
s_branch L_kj7
L_kb7:
buffer_load_dwordx4 v[168:171], v1, s[28:31], 0 offen nt
buffer_load_dwordx4 v[172:175], v1, s[28:31], s36 offen nt
buffer_load_dwordx4 v[176:179], v1, s[28:31], s37 offen nt
buffer_load_dwordx4 v[180:183], v1, s[28:31], s38 offen nt
v_add_u32 v1, 0x4000, v1
v_and_b32 v3, 0x8000, v1
v_add_u32 v1, v3, v1
v_and_b32 v1, 0xfffff, v1
L_kj7:
v_add_f32_dpp v16, v12, v12 row_ror:8 row_mask:0xf bank_mask:0x3
v_add_f32_dpp v17, v14, v14 row_ror:8 row_mask:0xf bank_mask:0x3
v_add_f32_dpp v16, v13, v13 row_ror:8 row_mask:0xf bank_mask:0xc
v_add_f32_dpp v17, v15, v15 row_ror:8 row_mask:0xf bank_mask:0xc
s_nop 0
v_add_f32_dpp v18, v16, v16 row_half_mirror row_mask:0xf bank_mask:0x5
v_add_f32_dpp v18, v17, v17 row_half_mirror row_mask:0xf bank_mask:0xa
s_nop 1
v_add_f32_dpp v18, v18, v18 quad_perm:[1,0,3,2] row_mask:0xf bank_mask:0xf
s_nop 1
v_add_f32_dpp v18, v18, v18 quad_perm:[2,3,0,1] row_mask:0xf bank_mask:0xf
v_cndmask_b32 v22, v22, v18, s[46:47]
v_cvt_pk_bf16_f32 v2, v22, v22
v_lshlrev_b32 v2, 16, v2
v_mul_f32 v2, s61, v2
v_cvt_pk_bf16_f32 v2, v2, v2
v_lshlrev_b32 v31, 16, v2
v_max_f32 v20, v20, v31
s_add_u32 s56, s56, 8
s_cmp_lt_u32 s56, 32
s_cbranch_scc1 L_kloop
s_nop 0
v_max_f32_dpp v20, v20, v20 row_ror:8 row_mask:0xf bank_mask:0xf
s_nop 1
v_max_f32_dpp v20, v20, v20 row_ror:4 row_mask:0xf bank_mask:0xf
s_nop 1
v_max_f32_dpp v20, v20, v20 row_ror:2 row_mask:0xf bank_mask:0xf
s_nop 1
v_max_f32_dpp v20, v20, v20 row_ror:1 row_mask:0xf bank_mask:0xf
v_mov_b32 v2, v20
s_nop 1
v_permlane32_swap_b32 v20, v2
v_max_f32 v20, v20, v2
v_mov_b32 v2, v20
s_nop 1
v_permlane16_swap_b32 v20, v2
v_max_f32 v20, v20, v2
v_mul_f32 v20, s60, v20
v_max_f32 v20, 0xff7fffff, v20
v_fma_f32 v24, v24, s60, -v20
v_fma_f32 v25, v25, s60, -v20
v_fma_f32 v26, v26, s60, -v20
v_fma_f32 v27, v27, s60, -v20
v_fma_f32 v28, v28, s60, -v20
v_fma_f32 v29, v29, s60, -v20
v_fma_f32 v30, v30, s60, -v20
v_fma_f32 v31, v31, s60, -v20
v_exp_f32 v24, v24
v_exp_f32 v25, v25
v_exp_f32 v26, v26
v_exp_f32 v27, v27
v_exp_f32 v28, v28
v_exp_f32 v29, v29
v_exp_f32 v30, v30
v_exp_f32 v31, v31
v_mov_b32 v8, 0
v_mov_b32 v9, 0
v_mov_b32 v10, 0
v_mov_b32 v11, 0
v_add_f32 v12, v24, v28
v_add_f32 v13, v25, v29
v_add_f32 v14, v26, v30
v_add_f32 v15, v27, v31
v_cvt_pk_bf16_f32 v24, v24, v24
v_cvt_pk_bf16_f32 v25, v25, v25
v_cvt_pk_bf16_f32 v26, v26, v26
v_cvt_pk_bf16_f32 v27, v27, v27
v_cvt_pk_bf16_f32 v28, v28, v28
v_cvt_pk_bf16_f32 v29, v29, v29
v_cvt_pk_bf16_f32 v30, v30, v30
v_cvt_pk_bf16_f32 v31, v31, v31
v_add_f32 v12, v12, v13
v_add_f32 v14, v14, v15
v_add_f32 v21, v12, v14
s_nop 1
v_add_f32_dpp v21, v21, v21 row_ror:8 row_mask:0xf bank_mask:0xf
s_nop 1
v_add_f32_dpp v21, v21, v21 row_ror:4 row_mask:0xf bank_mask:0xf
s_nop 1
v_add_f32_dpp v21, v21, v21 row_ror:2 row_mask:0xf bank_mask:0xf
s_nop 1
v_add_f32_dpp v21, v21, v21 row_ror:1 row_mask:0xf bank_mask:0xf
v_mov_b32 v2, v21
s_nop 1
v_permlane32_swap_b32 v21, v2
v_add_f32 v21, v21, v2
v_mov_b32 v2, v21
s_nop 1
v_permlane16_swap_b32 v21, v2
v_add_f32 v21, v21, v2
s_lshl_b32 s3, s19, 5
v_lshl_add_u32 v2, v185, 1, s3
s_mov_b64 exec, 1
ds_write_b64 v2, v[20:21] offset:6656
s_mul_i32 s3, s19, 3
s_add_u32 s3, s3, 1
v_mov_b32 v22, s3
s_mov_b64 exec, 1
ds_write_b32 v185, v22 offset:6720
s_mov_b64 exec, -1
s_mov_b32 s56, 0
L_vloop:
s_cmp_eq_u32 s56, 24
s_cbranch_scc0 L_v1
s_mov_b32 s28, s34
s_mov_b32 s29, s35
s_mov_b32 s30, s62
s_mul_i32 s3, s19, 3
s_add_u32 s3, s3, 2
v_mov_b32 v22, s3
s_mov_b64 exec, 1
ds_write_b32 v185, v22 offset:6720
s_mov_b64 exec, -1
L_v1:
s_mov_b64 exec, 1
ds_add_u32 v186, v187 offset:6768
ds_read_b64 v[188:189], v186 offset:6768
s_add_u32 s59, s59, 4
s_mov_b64 exec, -1
v_and_b32_dpp v40, v24, v4 row_newbcast:0 row_mask:0xf bank_mask:0xf
v_and_b32_dpp v41, v24, v5 row_newbcast:0 row_mask:0xf bank_mask:0xf
v_and_b32_dpp v42, v24, v6 row_newbcast:0 row_mask:0xf bank_mask:0xf
v_and_b32_dpp v43, v24, v7 row_newbcast:0 row_mask:0xf bank_mask:0xf
v_and_b32_dpp v44, v24, v4 row_newbcast:8 row_mask:0xf bank_mask:0xf
v_and_b32_dpp v45, v24, v5 row_newbcast:8 row_mask:0xf bank_mask:0xf
v_and_b32_dpp v46, v24, v6 row_newbcast:8 row_mask:0xf bank_mask:0xf
v_and_b32_dpp v47, v24, v7 row_newbcast:8 row_mask:0xf bank_mask:0xf
v_and_b32_dpp v48, v24, v4 row_newbcast:4 row_mask:0xf bank_mask:0xf
v_and_b32_dpp v49, v24, v5 row_newbcast:4 row_mask:0xf bank_mask:0xf
v_and_b32_dpp v50, v24, v6 row_newbcast:4 row_mask:0xf bank_mask:0xf
v_and_b32_dpp v51, v24, v7 row_newbcast:4 row_mask:0xf bank_mask:0xf
v_and_b32_dpp v52, v24, v4 row_newbcast:12 row_mask:0xf bank_mask:0xf
v_and_b32_dpp v53, v24, v5 row_newbcast:12 row_mask:0xf bank_mask:0xf
v_and_b32_dpp v54, v24, v6 row_newbcast:12 row_mask:0xf bank_mask:0xf
v_and_b32_dpp v55, v24, v7 row_newbcast:12 row_mask:0xf bank_mask:0xf
s_waitcnt vmcnt(28)
v_mfma_f32_16x16x32_bf16 v[8:11], v[40:43], v[56:59], v[8:11]
v_mfma_f32_16x16x32_bf16 v[8:11], v[44:47], v[60:63], v[8:11]
v_mfma_f32_16x16x32_bf16 v[8:11], v[48:51], v[64:67], v[8:11]
v_mfma_f32_16x16x32_bf16 v[8:11], v[52:55], v[68:71], v[8:11]
s_add_u32 s3, s56, 0
s_cmp_lt_u32 s3, s58
s_cbranch_scc0 L_v0n
s_waitcnt lgkmcnt(0)
v_readfirstlane_b32 s3, v188
v_readfirstlane_b32 s39, v189
s_sub_i32 s3, s3, s59
s_cmp_ge_i32 s3, 1
s_cselect_b32 s3, 1, s39
s_cmp_eq_u32 s3, 1
s_cbranch_scc1 L_vd0_0
s_waitcnt vmcnt(4)
L_vd0_0:
s_waitcnt vmcnt(5)
buffer_load_dwordx4 v[56:59], v1, s[28:31], 0 offen nt
s_cbranch_scc1 L_vd0_1
s_waitcnt vmcnt(4)
L_vd0_1:
s_waitcnt vmcnt(5)
buffer_load_dwordx4 v[60:63], v1, s[28:31], s36 offen nt
s_cbranch_scc1 L_vd0_2
s_waitcnt vmcnt(4)
L_vd0_2:
s_waitcnt vmcnt(5)
buffer_load_dwordx4 v[64:67], v1, s[28:31], s37 offen nt
s_cbranch_scc1 L_vd0_3
s_waitcnt vmcnt(4)
L_vd0_3:
s_waitcnt vmcnt(5)
buffer_load_dwordx4 v[68:71], v1, s[28:31], s38 offen nt
v_add_u32 v1, 0x4000, v1
v_and_b32 v3, 0x8000, v1
v_add_u32 v1, v3, v1
v_and_b32 v1, 0xfffff, v1
s_branch L_v0j
L_v0n:
buffer_load_dwordx4 v[56:59], v1, s[28:31], 0 offen nt
buffer_load_dwordx4 v[60:63], v1, s[28:31], s36 offen nt
buffer_load_dwordx4 v[64:67], v1, s[28:31], s37 offen nt
buffer_load_dwordx4 v[68:71], v1, s[28:31], s38 offen nt
v_add_u32 v1, 0x4000, v1
v_and_b32 v3, 0x8000, v1
v_add_u32 v1, v3, v1
v_and_b32 v1, 0xfffff, v1
L_v0j:
s_mov_b64 exec, 1
ds_add_u32 v186, v187 offset:6768
ds_read_b64 v[188:189], v186 offset:6768
s_add_u32 s59, s59, 4
s_mov_b64 exec, -1
v_and_b32_dpp v40, v24, v4 row_newbcast:1 row_mask:0xf bank_mask:0xf
v_and_b32_dpp v41, v24, v5 row_newbcast:1 row_mask:0xf bank_mask:0xf
v_and_b32_dpp v42, v24, v6 row_newbcast:1 row_mask:0xf bank_mask:0xf
v_and_b32_dpp v43, v24, v7 row_newbcast:1 row_mask:0xf bank_mask:0xf
v_and_b32_dpp v44, v24, v4 row_newbcast:9 row_mask:0xf bank_mask:0xf
v_and_b32_dpp v45, v24, v5 row_newbcast:9 row_mask:0xf bank_mask:0xf
v_and_b32_dpp v46, v24, v6 row_newbcast:9 row_mask:0xf bank_mask:0xf
v_and_b32_dpp v47, v24, v7 row_newbcast:9 row_mask:0xf bank_mask:0xf
v_and_b32_dpp v48, v24, v4 row_newbcast:5 row_mask:0xf bank_mask:0xf
v_and_b32_dpp v49, v24, v5 row_newbcast:5 row_mask:0xf bank_mask:0xf
v_and_b32_dpp v50, v24, v6 row_newbcast:5 row_mask:0xf bank_mask:0xf
v_and_b32_dpp v51, v24, v7 row_newbcast:5 row_mask:0xf bank_mask:0xf
v_and_b32_dpp v52, v24, v4 row_newbcast:13 row_mask:0xf bank_mask:0xf
v_and_b32_dpp v53, v24, v5 row_newbcast:13 row_mask:0xf bank_mask:0xf
v_and_b32_dpp v54, v24, v6 row_newbcast:13 row_mask:0xf bank_mask:0xf
v_and_b32_dpp v55, v24, v7 row_newbcast:13 row_mask:0xf bank_mask:0xf
s_waitcnt vmcnt(28)
v_mfma_f32_16x16x32_bf16 v[8:11], v[40:43], v[72:75], v[8:11]
v_mfma_f32_16x16x32_bf16 v[8:11], v[44:47], v[76:79], v[8:11]
v_mfma_f32_16x16x32_bf16 v[8:11], v[48:51], v[80:83], v[8:11]
v_mfma_f32_16x16x32_bf16 v[8:11], v[52:55], v[84:87], v[8:11]
s_add_u32 s3, s56, 1
s_cmp_lt_u32 s3, s58
s_cbranch_scc0 L_v1n
s_waitcnt lgkmcnt(0)
v_readfirstlane_b32 s3, v188
v_readfirstlane_b32 s39, v189
s_sub_i32 s3, s3, s59
s_cmp_ge_i32 s3, 1
s_cselect_b32 s3, 1, s39
s_cmp_eq_u32 s3, 1
s_cbranch_scc1 L_vd1_0
s_waitcnt vmcnt(4)
L_vd1_0:
s_waitcnt vmcnt(5)
buffer_load_dwordx4 v[72:75], v1, s[28:31], 0 offen nt
s_cbranch_scc1 L_vd1_1
s_waitcnt vmcnt(4)
L_vd1_1:
s_waitcnt vmcnt(5)
buffer_load_dwordx4 v[76:79], v1, s[28:31], s36 offen nt
s_cbranch_scc1 L_vd1_2
s_waitcnt vmcnt(4)
L_vd1_2:
s_waitcnt vmcnt(5)
buffer_load_dwordx4 v[80:83], v1, s[28:31], s37 offen nt
s_cbranch_scc1 L_vd1_3
s_waitcnt vmcnt(4)
L_vd1_3:
s_waitcnt vmcnt(5)
buffer_load_dwordx4 v[84:87], v1, s[28:31], s38 offen nt
v_add_u32 v1, 0x4000, v1
v_and_b32 v3, 0x8000, v1
v_add_u32 v1, v3, v1
v_and_b32 v1, 0xfffff, v1
s_branch L_v1j
L_v1n:
buffer_load_dwordx4 v[72:75], v1, s[28:31], 0 offen nt
buffer_load_dwordx4 v[76:79], v1, s[28:31], s36 offen nt
buffer_load_dwordx4 v[80:83], v1, s[28:31], s37 offen nt
buffer_load_dwordx4 v[84:87], v1, s[28:31], s38 offen nt
v_add_u32 v1, 0x4000, v1
v_and_b32 v3, 0x8000, v1
v_add_u32 v1, v3, v1
v_and_b32 v1, 0xfffff, v1
L_v1j:
s_mov_b64 exec, 1
ds_add_u32 v186, v187 offset:6768
ds_read_b64 v[188:189], v186 offset:6768
s_add_u32 s59, s59, 4
s_mov_b64 exec, -1
v_and_b32_dpp v40, v24, v4 row_newbcast:2 row_mask:0xf bank_mask:0xf
v_and_b32_dpp v41, v24, v5 row_newbcast:2 row_mask:0xf bank_mask:0xf
v_and_b32_dpp v42, v24, v6 row_newbcast:2 row_mask:0xf bank_mask:0xf
v_and_b32_dpp v43, v24, v7 row_newbcast:2 row_mask:0xf bank_mask:0xf
v_and_b32_dpp v44, v24, v4 row_newbcast:10 row_mask:0xf bank_mask:0xf
v_and_b32_dpp v45, v24, v5 row_newbcast:10 row_mask:0xf bank_mask:0xf
v_and_b32_dpp v46, v24, v6 row_newbcast:10 row_mask:0xf bank_mask:0xf
v_and_b32_dpp v47, v24, v7 row_newbcast:10 row_mask:0xf bank_mask:0xf
v_and_b32_dpp v48, v24, v4 row_newbcast:6 row_mask:0xf bank_mask:0xf
v_and_b32_dpp v49, v24, v5 row_newbcast:6 row_mask:0xf bank_mask:0xf
v_and_b32_dpp v50, v24, v6 row_newbcast:6 row_mask:0xf bank_mask:0xf
v_and_b32_dpp v51, v24, v7 row_newbcast:6 row_mask:0xf bank_mask:0xf
v_and_b32_dpp v52, v24, v4 row_newbcast:14 row_mask:0xf bank_mask:0xf
v_and_b32_dpp v53, v24, v5 row_newbcast:14 row_mask:0xf bank_mask:0xf
v_and_b32_dpp v54, v24, v6 row_newbcast:14 row_mask:0xf bank_mask:0xf
v_and_b32_dpp v55, v24, v7 row_newbcast:14 row_mask:0xf bank_mask:0xf
s_waitcnt vmcnt(28)
v_mfma_f32_16x16x32_bf16 v[8:11], v[40:43], v[88:91], v[8:11]
v_mfma_f32_16x16x32_bf16 v[8:11], v[44:47], v[92:95], v[8:11]
v_mfma_f32_16x16x32_bf16 v[8:11], v[48:51], v[96:99], v[8:11]
v_mfma_f32_16x16x32_bf16 v[8:11], v[52:55], v[100:103], v[8:11]
s_add_u32 s3, s56, 2
s_cmp_lt_u32 s3, s58
s_cbranch_scc0 L_v2n
s_waitcnt lgkmcnt(0)
v_readfirstlane_b32 s3, v188
v_readfirstlane_b32 s39, v189
s_sub_i32 s3, s3, s59
s_cmp_ge_i32 s3, 1
s_cselect_b32 s3, 1, s39
s_cmp_eq_u32 s3, 1
s_cbranch_scc1 L_vd2_0
s_waitcnt vmcnt(4)
L_vd2_0:
s_waitcnt vmcnt(5)
buffer_load_dwordx4 v[88:91], v1, s[28:31], 0 offen nt
s_cbranch_scc1 L_vd2_1
s_waitcnt vmcnt(4)
L_vd2_1:
s_waitcnt vmcnt(5)
buffer_load_dwordx4 v[92:95], v1, s[28:31], s36 offen nt
s_cbranch_scc1 L_vd2_2
s_waitcnt vmcnt(4)
L_vd2_2:
s_waitcnt vmcnt(5)
buffer_load_dwordx4 v[96:99], v1, s[28:31], s37 offen nt
s_cbranch_scc1 L_vd2_3
s_waitcnt vmcnt(4)
L_vd2_3:
s_waitcnt vmcnt(5)
buffer_load_dwordx4 v[100:103], v1, s[28:31], s38 offen nt
v_add_u32 v1, 0x4000, v1
v_and_b32 v3, 0x8000, v1
v_add_u32 v1, v3, v1
v_and_b32 v1, 0xfffff, v1
s_branch L_v2j
L_v2n:
buffer_load_dwordx4 v[88:91], v1, s[28:31], 0 offen nt
buffer_load_dwordx4 v[92:95], v1, s[28:31], s36 offen nt
buffer_load_dwordx4 v[96:99], v1, s[28:31], s37 offen nt
buffer_load_dwordx4 v[100:103], v1, s[28:31], s38 offen nt
v_add_u32 v1, 0x4000, v1
v_and_b32 v3, 0x8000, v1
v_add_u32 v1, v3, v1
v_and_b32 v1, 0xfffff, v1
L_v2j:
s_mov_b64 exec, 1
ds_add_u32 v186, v187 offset:6768
ds_read_b64 v[188:189], v186 offset:6768
s_add_u32 s59, s59, 4
s_mov_b64 exec, -1
v_and_b32_dpp v40, v24, v4 row_newbcast:3 row_mask:0xf bank_mask:0xf
v_and_b32_dpp v41, v24, v5 row_newbcast:3 row_mask:0xf bank_mask:0xf
v_and_b32_dpp v42, v24, v6 row_newbcast:3 row_mask:0xf bank_mask:0xf
v_and_b32_dpp v43, v24, v7 row_newbcast:3 row_mask:0xf bank_mask:0xf
v_and_b32_dpp v44, v24, v4 row_newbcast:11 row_mask:0xf bank_mask:0xf
v_and_b32_dpp v45, v24, v5 row_newbcast:11 row_mask:0xf bank_mask:0xf
v_and_b32_dpp v46, v24, v6 row_newbcast:11 row_mask:0xf bank_mask:0xf
v_and_b32_dpp v47, v24, v7 row_newbcast:11 row_mask:0xf bank_mask:0xf
v_and_b32_dpp v48, v24, v4 row_newbcast:7 row_mask:0xf bank_mask:0xf
v_and_b32_dpp v49, v24, v5 row_newbcast:7 row_mask:0xf bank_mask:0xf
v_and_b32_dpp v50, v24, v6 row_newbcast:7 row_mask:0xf bank_mask:0xf
v_and_b32_dpp v51, v24, v7 row_newbcast:7 row_mask:0xf bank_mask:0xf
v_and_b32_dpp v52, v24, v4 row_newbcast:15 row_mask:0xf bank_mask:0xf
v_and_b32_dpp v53, v24, v5 row_newbcast:15 row_mask:0xf bank_mask:0xf
v_and_b32_dpp v54, v24, v6 row_newbcast:15 row_mask:0xf bank_mask:0xf
v_and_b32_dpp v55, v24, v7 row_newbcast:15 row_mask:0xf bank_mask:0xf
s_waitcnt vmcnt(28)
v_mfma_f32_16x16x32_bf16 v[8:11], v[40:43], v[104:107], v[8:11]
v_mfma_f32_16x16x32_bf16 v[8:11], v[44:47], v[108:111], v[8:11]
v_mfma_f32_16x16x32_bf16 v[8:11], v[48:51], v[112:115], v[8:11]
v_mfma_f32_16x16x32_bf16 v[8:11], v[52:55], v[116:119], v[8:11]
s_add_u32 s3, s56, 3
s_cmp_lt_u32 s3, s58
s_cbranch_scc0 L_v3n
s_waitcnt lgkmcnt(0)
v_readfirstlane_b32 s3, v188
v_readfirstlane_b32 s39, v189
s_sub_i32 s3, s3, s59
s_cmp_ge_i32 s3, 1
s_cselect_b32 s3, 1, s39
s_cmp_eq_u32 s3, 1
s_cbranch_scc1 L_vd3_0
s_waitcnt vmcnt(4)
L_vd3_0:
s_waitcnt vmcnt(5)
buffer_load_dwordx4 v[104:107], v1, s[28:31], 0 offen nt
s_cbranch_scc1 L_vd3_1
s_waitcnt vmcnt(4)
L_vd3_1:
s_waitcnt vmcnt(5)
buffer_load_dwordx4 v[108:111], v1, s[28:31], s36 offen nt
s_cbranch_scc1 L_vd3_2
s_waitcnt vmcnt(4)
L_vd3_2:
s_waitcnt vmcnt(5)
buffer_load_dwordx4 v[112:115], v1, s[28:31], s37 offen nt
s_cbranch_scc1 L_vd3_3
s_waitcnt vmcnt(4)
L_vd3_3:
s_waitcnt vmcnt(5)
buffer_load_dwordx4 v[116:119], v1, s[28:31], s38 offen nt
v_add_u32 v1, 0x4000, v1
v_and_b32 v3, 0x8000, v1
v_add_u32 v1, v3, v1
v_and_b32 v1, 0xfffff, v1
s_branch L_v3j
L_v3n:
buffer_load_dwordx4 v[104:107], v1, s[28:31], 0 offen nt
buffer_load_dwordx4 v[108:111], v1, s[28:31], s36 offen nt
buffer_load_dwordx4 v[112:115], v1, s[28:31], s37 offen nt
buffer_load_dwordx4 v[116:119], v1, s[28:31], s38 offen nt
v_add_u32 v1, 0x4000, v1
v_and_b32 v3, 0x8000, v1
v_add_u32 v1, v3, v1
v_and_b32 v1, 0xfffff, v1
L_v3j:
s_mov_b64 exec, 1
ds_add_u32 v186, v187 offset:6768
ds_read_b64 v[188:189], v186 offset:6768
s_add_u32 s59, s59, 4
s_mov_b64 exec, -1
v_and_b32_dpp v40, v25, v4 row_newbcast:0 row_mask:0xf bank_mask:0xf
v_and_b32_dpp v41, v25, v5 row_newbcast:0 row_mask:0xf bank_mask:0xf
v_and_b32_dpp v42, v25, v6 row_newbcast:0 row_mask:0xf bank_mask:0xf
v_and_b32_dpp v43, v25, v7 row_newbcast:0 row_mask:0xf bank_mask:0xf
v_and_b32_dpp v44, v25, v4 row_newbcast:8 row_mask:0xf bank_mask:0xf
v_and_b32_dpp v45, v25, v5 row_newbcast:8 row_mask:0xf bank_mask:0xf
v_and_b32_dpp v46, v25, v6 row_newbcast:8 row_mask:0xf bank_mask:0xf
v_and_b32_dpp v47, v25, v7 row_newbcast:8 row_mask:0xf bank_mask:0xf
v_and_b32_dpp v48, v25, v4 row_newbcast:4 row_mask:0xf bank_mask:0xf
v_and_b32_dpp v49, v25, v5 row_newbcast:4 row_mask:0xf bank_mask:0xf
v_and_b32_dpp v50, v25, v6 row_newbcast:4 row_mask:0xf bank_mask:0xf
v_and_b32_dpp v51, v25, v7 row_newbcast:4 row_mask:0xf bank_mask:0xf
v_and_b32_dpp v52, v25, v4 row_newbcast:12 row_mask:0xf bank_mask:0xf
v_and_b32_dpp v53, v25, v5 row_newbcast:12 row_mask:0xf bank_mask:0xf
v_and_b32_dpp v54, v25, v6 row_newbcast:12 row_mask:0xf bank_mask:0xf
v_and_b32_dpp v55, v25, v7 row_newbcast:12 row_mask:0xf bank_mask:0xf
s_waitcnt vmcnt(28)
v_mfma_f32_16x16x32_bf16 v[8:11], v[40:43], v[120:123], v[8:11]
v_mfma_f32_16x16x32_bf16 v[8:11], v[44:47], v[124:127], v[8:11]
v_mfma_f32_16x16x32_bf16 v[8:11], v[48:51], v[128:131], v[8:11]
v_mfma_f32_16x16x32_bf16 v[8:11], v[52:55], v[132:135], v[8:11]
s_add_u32 s3, s56, 4
s_cmp_lt_u32 s3, s58
s_cbranch_scc0 L_v4n
s_waitcnt lgkmcnt(0)
v_readfirstlane_b32 s3, v188
v_readfirstlane_b32 s39, v189
s_sub_i32 s3, s3, s59
s_cmp_ge_i32 s3, 1
s_cselect_b32 s3, 1, s39
s_cmp_eq_u32 s3, 1
s_cbranch_scc1 L_vd4_0
s_waitcnt vmcnt(4)
L_vd4_0:
s_waitcnt vmcnt(5)
buffer_load_dwordx4 v[120:123], v1, s[28:31], 0 offen nt
s_cbranch_scc1 L_vd4_1
s_waitcnt vmcnt(4)
L_vd4_1:
s_waitcnt vmcnt(5)
buffer_load_dwordx4 v[124:127], v1, s[28:31], s36 offen nt
s_cbranch_scc1 L_vd4_2
s_waitcnt vmcnt(4)
L_vd4_2:
s_waitcnt vmcnt(5)
buffer_load_dwordx4 v[128:131], v1, s[28:31], s37 offen nt
s_cbranch_scc1 L_vd4_3
s_waitcnt vmcnt(4)
L_vd4_3:
s_waitcnt vmcnt(5)
buffer_load_dwordx4 v[132:135], v1, s[28:31], s38 offen nt
v_add_u32 v1, 0x4000, v1
v_and_b32 v3, 0x8000, v1
v_add_u32 v1, v3, v1
v_and_b32 v1, 0xfffff, v1
s_branch L_v4j
L_v4n:
buffer_load_dwordx4 v[120:123], v1, s[28:31], 0 offen nt
buffer_load_dwordx4 v[124:127], v1, s[28:31], s36 offen nt
buffer_load_dwordx4 v[128:131], v1, s[28:31], s37 offen nt
buffer_load_dwordx4 v[132:135], v1, s[28:31], s38 offen nt
v_add_u32 v1, 0x4000, v1
v_and_b32 v3, 0x8000, v1
v_add_u32 v1, v3, v1
v_and_b32 v1, 0xfffff, v1
L_v4j:
s_mov_b64 exec, 1
ds_add_u32 v186, v187 offset:6768
ds_read_b64 v[188:189], v186 offset:6768
s_add_u32 s59, s59, 4
s_mov_b64 exec, -1
v_and_b32_dpp v40, v25, v4 row_newbcast:1 row_mask:0xf bank_mask:0xf
v_and_b32_dpp v41, v25, v5 row_newbcast:1 row_mask:0xf bank_mask:0xf
v_and_b32_dpp v42, v25, v6 row_newbcast:1 row_mask:0xf bank_mask:0xf
v_and_b32_dpp v43, v25, v7 row_newbcast:1 row_mask:0xf bank_mask:0xf
v_and_b32_dpp v44, v25, v4 row_newbcast:9 row_mask:0xf bank_mask:0xf
v_and_b32_dpp v45, v25, v5 row_newbcast:9 row_mask:0xf bank_mask:0xf
v_and_b32_dpp v46, v25, v6 row_newbcast:9 row_mask:0xf bank_mask:0xf
v_and_b32_dpp v47, v25, v7 row_newbcast:9 row_mask:0xf bank_mask:0xf
v_and_b32_dpp v48, v25, v4 row_newbcast:5 row_mask:0xf bank_mask:0xf
v_and_b32_dpp v49, v25, v5 row_newbcast:5 row_mask:0xf bank_mask:0xf
v_and_b32_dpp v50, v25, v6 row_newbcast:5 row_mask:0xf bank_mask:0xf
v_and_b32_dpp v51, v25, v7 row_newbcast:5 row_mask:0xf bank_mask:0xf
v_and_b32_dpp v52, v25, v4 row_newbcast:13 row_mask:0xf bank_mask:0xf
v_and_b32_dpp v53, v25, v5 row_newbcast:13 row_mask:0xf bank_mask:0xf
v_and_b32_dpp v54, v25, v6 row_newbcast:13 row_mask:0xf bank_mask:0xf
v_and_b32_dpp v55, v25, v7 row_newbcast:13 row_mask:0xf bank_mask:0xf
s_waitcnt vmcnt(28)
v_mfma_f32_16x16x32_bf16 v[8:11], v[40:43], v[136:139], v[8:11]
v_mfma_f32_16x16x32_bf16 v[8:11], v[44:47], v[140:143], v[8:11]
v_mfma_f32_16x16x32_bf16 v[8:11], v[48:51], v[144:147], v[8:11]
v_mfma_f32_16x16x32_bf16 v[8:11], v[52:55], v[148:151], v[8:11]
s_add_u32 s3, s56, 5
s_cmp_lt_u32 s3, s58
s_cbranch_scc0 L_v5n
s_waitcnt lgkmcnt(0)
v_readfirstlane_b32 s3, v188
v_readfirstlane_b32 s39, v189
s_sub_i32 s3, s3, s59
s_cmp_ge_i32 s3, 1
s_cselect_b32 s3, 1, s39
s_cmp_eq_u32 s3, 1
s_cbranch_scc1 L_vd5_0
s_waitcnt vmcnt(4)
L_vd5_0:
s_waitcnt vmcnt(5)
buffer_load_dwordx4 v[136:139], v1, s[28:31], 0 offen nt
s_cbranch_scc1 L_vd5_1
s_waitcnt vmcnt(4)
L_vd5_1:
s_waitcnt vmcnt(5)
buffer_load_dwordx4 v[140:143], v1, s[28:31], s36 offen nt
s_cbranch_scc1 L_vd5_2
s_waitcnt vmcnt(4)
L_vd5_2:
s_waitcnt vmcnt(5)
buffer_load_dwordx4 v[144:147], v1, s[28:31], s37 offen nt
s_cbranch_scc1 L_vd5_3
s_waitcnt vmcnt(4)
L_vd5_3:
s_waitcnt vmcnt(5)
buffer_load_dwordx4 v[148:151], v1, s[28:31], s38 offen nt
v_add_u32 v1, 0x4000, v1
v_and_b32 v3, 0x8000, v1
v_add_u32 v1, v3, v1
v_and_b32 v1, 0xfffff, v1
s_branch L_v5j
L_v5n:
buffer_load_dwordx4 v[136:139], v1, s[28:31], 0 offen nt
buffer_load_dwordx4 v[140:143], v1, s[28:31], s36 offen nt
buffer_load_dwordx4 v[144:147], v1, s[28:31], s37 offen nt
buffer_load_dwordx4 v[148:151], v1, s[28:31], s38 offen nt
v_add_u32 v1, 0x4000, v1
v_and_b32 v3, 0x8000, v1
v_add_u32 v1, v3, v1
v_and_b32 v1, 0xfffff, v1
L_v5j:
s_mov_b64 exec, 1
ds_add_u32 v186, v187 offset:6768
ds_read_b64 v[188:189], v186 offset:6768
s_add_u32 s59, s59, 4
s_mov_b64 exec, -1
v_and_b32_dpp v40, v25, v4 row_newbcast:2 row_mask:0xf bank_mask:0xf
v_and_b32_dpp v41, v25, v5 row_newbcast:2 row_mask:0xf bank_mask:0xf
v_and_b32_dpp v42, v25, v6 row_newbcast:2 row_mask:0xf bank_mask:0xf
v_and_b32_dpp v43, v25, v7 row_newbcast:2 row_mask:0xf bank_mask:0xf
v_and_b32_dpp v44, v25, v4 row_newbcast:10 row_mask:0xf bank_mask:0xf
v_and_b32_dpp v45, v25, v5 row_newbcast:10 row_mask:0xf bank_mask:0xf
v_and_b32_dpp v46, v25, v6 row_newbcast:10 row_mask:0xf bank_mask:0xf
v_and_b32_dpp v47, v25, v7 row_newbcast:10 row_mask:0xf bank_mask:0xf
v_and_b32_dpp v48, v25, v4 row_newbcast:6 row_mask:0xf bank_mask:0xf
v_and_b32_dpp v49, v25, v5 row_newbcast:6 row_mask:0xf bank_mask:0xf
v_and_b32_dpp v50, v25, v6 row_newbcast:6 row_mask:0xf bank_mask:0xf
v_and_b32_dpp v51, v25, v7 row_newbcast:6 row_mask:0xf bank_mask:0xf
v_and_b32_dpp v52, v25, v4 row_newbcast:14 row_mask:0xf bank_mask:0xf
v_and_b32_dpp v53, v25, v5 row_newbcast:14 row_mask:0xf bank_mask:0xf
v_and_b32_dpp v54, v25, v6 row_newbcast:14 row_mask:0xf bank_mask:0xf
v_and_b32_dpp v55, v25, v7 row_newbcast:14 row_mask:0xf bank_mask:0xf
s_waitcnt vmcnt(28)
v_mfma_f32_16x16x32_bf16 v[8:11], v[40:43], v[152:155], v[8:11]
v_mfma_f32_16x16x32_bf16 v[8:11], v[44:47], v[156:159], v[8:11]
v_mfma_f32_16x16x32_bf16 v[8:11], v[48:51], v[160:163], v[8:11]
v_mfma_f32_16x16x32_bf16 v[8:11], v[52:55], v[164:167], v[8:11]
s_add_u32 s3, s56, 6
s_cmp_lt_u32 s3, s58
s_cbranch_scc0 L_v6n
s_waitcnt lgkmcnt(0)
v_readfirstlane_b32 s3, v188
v_readfirstlane_b32 s39, v189
s_sub_i32 s3, s3, s59
s_cmp_ge_i32 s3, 1
s_cselect_b32 s3, 1, s39
s_cmp_eq_u32 s3, 1
s_cbranch_scc1 L_vd6_0
s_waitcnt vmcnt(4)
L_vd6_0:
s_waitcnt vmcnt(5)
buffer_load_dwordx4 v[152:155], v1, s[28:31], 0 offen nt
s_cbranch_scc1 L_vd6_1
s_waitcnt vmcnt(4)
L_vd6_1:
s_waitcnt vmcnt(5)
buffer_load_dwordx4 v[156:159], v1, s[28:31], s36 offen nt
s_cbranch_scc1 L_vd6_2
s_waitcnt vmcnt(4)
L_vd6_2:
s_waitcnt vmcnt(5)
buffer_load_dwordx4 v[160:163], v1, s[28:31], s37 offen nt
s_cbranch_scc1 L_vd6_3
s_waitcnt vmcnt(4)
L_vd6_3:
s_waitcnt vmcnt(5)
buffer_load_dwordx4 v[164:167], v1, s[28:31], s38 offen nt
v_add_u32 v1, 0x4000, v1
v_and_b32 v3, 0x8000, v1
v_add_u32 v1, v3, v1
v_and_b32 v1, 0xfffff, v1
s_branch L_v6j
L_v6n:
buffer_load_dwordx4 v[152:155], v1, s[28:31], 0 offen nt
buffer_load_dwordx4 v[156:159], v1, s[28:31], s36 offen nt
buffer_load_dwordx4 v[160:163], v1, s[28:31], s37 offen nt
buffer_load_dwordx4 v[164:167], v1, s[28:31], s38 offen nt
v_add_u32 v1, 0x4000, v1
v_and_b32 v3, 0x8000, v1
v_add_u32 v1, v3, v1
v_and_b32 v1, 0xfffff, v1
L_v6j:
s_mov_b64 exec, 1
ds_add_u32 v186, v187 offset:6768
ds_read_b64 v[188:189], v186 offset:6768
s_add_u32 s59, s59, 4
s_mov_b64 exec, -1
v_and_b32_dpp v40, v25, v4 row_newbcast:3 row_mask:0xf bank_mask:0xf
v_and_b32_dpp v41, v25, v5 row_newbcast:3 row_mask:0xf bank_mask:0xf
v_and_b32_dpp v42, v25, v6 row_newbcast:3 row_mask:0xf bank_mask:0xf
v_and_b32_dpp v43, v25, v7 row_newbcast:3 row_mask:0xf bank_mask:0xf
v_and_b32_dpp v44, v25, v4 row_newbcast:11 row_mask:0xf bank_mask:0xf
v_and_b32_dpp v45, v25, v5 row_newbcast:11 row_mask:0xf bank_mask:0xf
v_and_b32_dpp v46, v25, v6 row_newbcast:11 row_mask:0xf bank_mask:0xf
v_and_b32_dpp v47, v25, v7 row_newbcast:11 row_mask:0xf bank_mask:0xf
v_and_b32_dpp v48, v25, v4 row_newbcast:7 row_mask:0xf bank_mask:0xf
v_and_b32_dpp v49, v25, v5 row_newbcast:7 row_mask:0xf bank_mask:0xf
v_and_b32_dpp v50, v25, v6 row_newbcast:7 row_mask:0xf bank_mask:0xf
v_and_b32_dpp v51, v25, v7 row_newbcast:7 row_mask:0xf bank_mask:0xf
v_and_b32_dpp v52, v25, v4 row_newbcast:15 row_mask:0xf bank_mask:0xf
v_and_b32_dpp v53, v25, v5 row_newbcast:15 row_mask:0xf bank_mask:0xf
v_and_b32_dpp v54, v25, v6 row_newbcast:15 row_mask:0xf bank_mask:0xf
v_and_b32_dpp v55, v25, v7 row_newbcast:15 row_mask:0xf bank_mask:0xf
s_waitcnt vmcnt(28)
v_mfma_f32_16x16x32_bf16 v[8:11], v[40:43], v[168:171], v[8:11]
v_mfma_f32_16x16x32_bf16 v[8:11], v[44:47], v[172:175], v[8:11]
v_mfma_f32_16x16x32_bf16 v[8:11], v[48:51], v[176:179], v[8:11]
v_mfma_f32_16x16x32_bf16 v[8:11], v[52:55], v[180:183], v[8:11]
s_add_u32 s3, s56, 7
s_cmp_lt_u32 s3, s58
s_cbranch_scc0 L_v7n
s_waitcnt lgkmcnt(0)
v_readfirstlane_b32 s3, v188
v_readfirstlane_b32 s39, v189
s_sub_i32 s3, s3, s59
s_cmp_ge_i32 s3, 1
s_cselect_b32 s3, 1, s39
s_cmp_eq_u32 s3, 1
s_cbranch_scc1 L_vd7_0
s_waitcnt vmcnt(4)
L_vd7_0:
s_waitcnt vmcnt(5)
buffer_load_dwordx4 v[168:171], v1, s[28:31], 0 offen nt
s_cbranch_scc1 L_vd7_1
s_waitcnt vmcnt(4)
L_vd7_1:
s_waitcnt vmcnt(5)
buffer_load_dwordx4 v[172:175], v1, s[28:31], s36 offen nt
s_cbranch_scc1 L_vd7_2
s_waitcnt vmcnt(4)
L_vd7_2:
s_waitcnt vmcnt(5)
buffer_load_dwordx4 v[176:179], v1, s[28:31], s37 offen nt
s_cbranch_scc1 L_vd7_3
s_waitcnt vmcnt(4)
L_vd7_3:
s_waitcnt vmcnt(5)
buffer_load_dwordx4 v[180:183], v1, s[28:31], s38 offen nt
v_add_u32 v1, 0x4000, v1
v_and_b32 v3, 0x8000, v1
v_add_u32 v1, v3, v1
v_and_b32 v1, 0xfffff, v1
s_branch L_v7j
L_v7n:
buffer_load_dwordx4 v[168:171], v1, s[28:31], 0 offen nt
buffer_load_dwordx4 v[172:175], v1, s[28:31], s36 offen nt
buffer_load_dwordx4 v[176:179], v1, s[28:31], s37 offen nt
buffer_load_dwordx4 v[180:183], v1, s[28:31], s38 offen nt
v_add_u32 v1, 0x4000, v1
v_and_b32 v3, 0x8000, v1
v_add_u32 v1, v3, v1
v_and_b32 v1, 0xfffff, v1
L_v7j:
s_add_u32 s56, s56, 8
s_cmp_lt_u32 s56, 32
s_cbranch_scc0 L_vdone
v_mov_b32 v24, v26
v_mov_b32 v25, v27
v_mov_b32 v26, v28
v_mov_b32 v27, v29
v_mov_b32 v28, v30
v_mov_b32 v29, v31
s_branch L_vloop
L_vdone:
s_mov_b32 exec_lo, 0xffffffff
s_mov_b32 exec_hi, 0x0
ds_write_b128 v19, v[8:11] offset:0
s_mul_i32 s3, s19, 3
s_add_u32 s3, s3, 3
v_mov_b32 v22, s3
s_mov_b64 exec, 1
ds_write_b32 v185, v22 offset:6720
s_mov_b64 exec, -1
s_cmp_eq_u32 s19, 0
s_cbranch_scc0 L_sdone
s_mov_b32 s19, 1
s_add_u32 s32, s72, s63
s_addc_u32 s33, s73, 0
s_mov_b32 s62, 0
s_mov_b32 s58, 16
v_add_u32 v19, 2048, v19
v_add_u32 v184, 256, v184
s_waitcnt lgkmcnt(0)
s_branch L_branch
L_sdone:
s_endpgm
L_helper:
s_lshl_b32 s3, s7, 2
v_mov_b32 v97, s3
v_mov_b32 v98, 0
s_mov_b64 exec, 1
ds_write_b32 v97, v98 offset:6720
ds_write_b32 v97, v98 offset:6736
ds_write_b32 v97, v98 offset:6752
ds_write_b32 v97, v98 offset:6768
s_mov_b64 exec, -1
s_bfe_u32 s26, s2, 0x30003
v_lshrrev_b32 v4, 4, v0
v_and_b32 v5, 15, v0
s_lshl_b32 s3, s4, 8
v_lshrrev_b32 v2, 2, v5
v_lshlrev_b32 v2, 10, v2
v_lshl_add_u32 v2, v4, 4, v2
v_add_u32 v99, s3, v2
s_lshl_b32 s3, s4, 2
s_add_u32 s3, s3, s7
s_lshl_b32 s3, s3, 18
s_lshl_b32 s57, s5, 8
s_add_u32 s3, s3, s57
s_lshl_b32 s57, s6, 7
s_add_u32 s3, s3, s57
v_lshrrev_b32 v2, 3, v0
v_and_b32 v3, 7, v0
v_lshlrev_b32 v3, 4, v3
v_lshl_add_u32 v100, v2, 13, v3
v_add_u32 v100, s3, v100
s_lshl_b32 s3, s5, 17
s_lshl_b32 s57, s7, 15
s_add_u32 s3, s3, s57
s_lshl_b32 s57, s26, 7
s_add_u32 s3, s3, s57
v_lshl_add_u32 v101, v2, 10, v3
v_add_u32 v101, s3, v101
s_lshl_b32 s3, s5, 13
s_add_u32 s38, s3, 0x100000
s_lshl_b32 s3, s26, 2
s_add_u32 s3, s3, s7
s_lshl_b32 s3, s3, 8
s_add_u32 s3, s3, s38
v_lshl_add_u32 v94, v0, 2, s3
s_lshl_b32 s39, s7, 12
s_mov_b32 s34, 0x1000
s_mov_b32 s35, 0x20000
s_mov_b32 s30, 0x400000
s_mov_b32 s31, 0x20000
s_waitcnt lgkmcnt(0)
s_load_dword s37, s[24:25], 0
s_mov_b32 s52, s16
s_mov_b32 s53, s17
s_mov_b32 s28, s14
s_mov_b32 s29, s15
s_add_u32 m0, s39, 8192
s_mov_b32 s3, 0
buffer_load_dwordx4 v100, s[28:31], s3 offen nt lds
s_add_u32 m0, s39, 9216
s_mov_b32 s3, 65536
buffer_load_dwordx4 v100, s[28:31], s3 offen nt lds
s_add_u32 m0, s39, 10240
s_mov_b32 s3, 131072
buffer_load_dwordx4 v100, s[28:31], s3 offen nt lds
s_add_u32 m0, s39, 11264
s_mov_b32 s3, 196608
buffer_load_dwordx4 v100, s[28:31], s3 offen nt lds
s_mov_b32 s32, s8
s_mov_b32 s33, s9
buffer_load_dwordx4 v[8:11], v99, s[32:35], 0 offen offset:0
buffer_load_dwordx4 v[12:15], v99, s[32:35], 0 offen offset:64
buffer_load_dwordx4 v[16:19], v99, s[32:35], 0 offen offset:128
buffer_load_dwordx4 v[20:23], v99, s[32:35], 0 offen offset:192
s_mov_b32 s44, s24
s_mov_b32 s45, s25
s_mov_b32 s46, 0x180000
s_mov_b32 s47, 0x20000
s_mov_b32 s3, 0x40000
s_mov_b32 exec_lo, 0x1
s_mov_b32 exec_hi, 0x1
buffer_load_dword v200, v94, s[44:47], 0 offen sc1
buffer_load_dword v201, v94, s[44:47], s3 offen sc1
s_mov_b64 exec, -1
s_barrier
v_bfe_u32 v2, v0, 2, 2
v_lshl_add_u32 v2, v4, 3, v2
v_and_b32 v3, 3, v0
v_lshlrev_b32 v3, 3, v3
s_lshl_b32 s3, s7, 5
s_add_u32 s3, s3, 8192
v_lshl_add_u32 v92, v2, 7, v3
v_add_u32 v92, s3, v92
v_add_u32 v93, 32768, v92
s_lshl_b32 s3, s7, 8
v_lshl_add_u32 v105, v0, 2, s3
v_lshlrev_b32 v110, 3, v0
s_lshl_b32 s3, s4, 6
s_add_u32 s3, s3, s38
s_add_u32 s62, s24, s3
s_addc_u32 s63, s25, 0
v_and_b32 v3, 3, v0
v_lshl_add_u32 v95, v3, 4, s3
v_bfe_u32 v3, v0, 2, 2
v_lshl_add_u32 v95, v3, 8, v95
v_bfe_u32 v3, v0, 4, 1
v_lshl_add_u32 v95, v3, 12, v95
v_lshrrev_b32 v3, 5, v0
v_lshl_add_u32 v95, v3, 10, v95
v_and_b32 v2, 31, v0
v_lshlrev_b32 v2, 3, v2
v_lshl_add_u32 v96, v3, 2, v2
s_waitcnt lgkmcnt(0)
s_add_u32 s37, s37, 1
v_mov_b32 v112, s37
s_and_b32 s3, s37, 0xff
v_mov_b32 v176, s3
v_mov_b32 v7, 0xffffff00
v_xor_b32 v177, 0xff, v176
v_xor_b32 v178, 0x55, v176
v_xor_b32 v179, 0xaa, v176
s_waitcnt vmcnt(2)
v_mov_b32 v3, 1
s_mov_b64 exec, 1
ds_write_b32 v97, v3 offset:6736
s_mov_b64 exec, -1
s_mov_b32 s56, 0x400000
L_q0:
ds_read_b128 v[124:127], v98 offset:6736
s_sub_u32 s56, s56, 1
s_cbranch_scc1 L_end
s_waitcnt lgkmcnt(0)
v_min3_u32 v124, v124, v125, v126
v_min_u32 v124, v124, v127
s_nop 0
v_readfirstlane_b32 s3, v124
s_cmp_ge_u32 s3, 1
s_cbranch_scc0 L_q0
ds_read_b64_tr_b16 v[40:41], v92 offset:0
ds_read_b64_tr_b16 v[42:43], v92 offset:512
ds_read_b64_tr_b16 v[44:45], v92 offset:4096
ds_read_b64_tr_b16 v[46:47], v92 offset:4608
ds_read_b64_tr_b16 v[48:49], v92 offset:8192
ds_read_b64_tr_b16 v[50:51], v92 offset:8704
ds_read_b64_tr_b16 v[52:53], v92 offset:12288
ds_read_b64_tr_b16 v[54:55], v92 offset:12800
s_waitcnt lgkmcnt(6)
v_mfma_f32_16x16x32_bf16 v[72:75], v[8:11], v[40:43], 0
s_waitcnt lgkmcnt(4)
v_mfma_f32_16x16x32_bf16 v[72:75], v[12:15], v[44:47], v[72:75]
s_waitcnt lgkmcnt(2)
v_mfma_f32_16x16x32_bf16 v[72:75], v[16:19], v[48:51], v[72:75]
s_waitcnt lgkmcnt(0)
v_mfma_f32_16x16x32_bf16 v[72:75], v[20:23], v[52:55], v[72:75]
s_nop 7
v_mov_b32_dpp v81, v72 quad_perm:[1,1,1,1] row_mask:0xf bank_mask:0xf
v_mov_b32_dpp v82, v72 quad_perm:[2,2,2,2] row_mask:0xf bank_mask:0xf
v_mov_b32_dpp v83, v72 quad_perm:[3,3,3,3] row_mask:0xf bank_mask:0xf
v_add_u32 v80, 0x80, v72
v_and_or_b32 v80, v80, v7, v176
v_add_u32 v81, 0x80, v81
v_and_or_b32 v81, v81, v7, v177
v_add_u32 v82, 0x80, v82
v_and_or_b32 v82, v82, v7, v178
v_add_u32 v83, 0x80, v83
v_and_or_b32 v83, v83, v7, v179
s_mov_b32 exec_lo, 0x11111111
s_mov_b32 exec_hi, 0x11111111
buffer_store_dwordx4 v[80:83], v94, s[44:47], 0 offen sc1
s_mov_b64 exec, -1
s_cmp_lg_u32 s7, 0
s_cbranch_scc1 L_qx0
s_mov_b32 s56, 0x40000
L_sq0:
s_load_dword s64, s[62:63], 0x300 glc
s_load_dword s65, s[62:63], 0x700 glc
s_load_dword s66, s[62:63], 0xb00 glc
s_load_dword s67, s[62:63], 0xf00 glc
s_load_dword s78, s[62:63], 0x1300 glc
s_load_dword s79, s[62:63], 0x1700 glc
s_load_dword s42, s[62:63], 0x1b00 glc
s_load_dword s43, s[62:63], 0x1f00 glc
s_sub_u32 s56, s56, 1
s_cbranch_scc1 L_end
s_waitcnt lgkmcnt(0)
s_xor_b32 s64, s64, s37
s_xor_b32 s65, s65, s37
s_xor_b32 s66, s66, s37
s_xor_b32 s67, s67, s37
s_xor_b32 s78, s78, s37
s_xor_b32 s79, s79, s37
s_xor_b32 s42, s42, s37
s_xor_b32 s43, s43, s37
s_or_b32 s64, s64, s65
s_or_b32 s64, s64, s66
s_or_b32 s64, s64, s67
s_or_b32 s64, s64, s78
s_or_b32 s64, s64, s79
s_or_b32 s64, s64, s42
s_or_b32 s64, s64, s43
s_and_b32 s64, s64, 0xff
s_cbranch_scc1 L_sq0
s_mov_b32 s56, 0x40000
L_qp0:
buffer_load_dwordx4 v[84:87], v95, s[44:47], 0 offen sc1
buffer_load_dwordx4 v[88:91], v95, s[44:47], 0 offen offset:2048 sc1
s_sub_u32 s56, s56, 1
s_cbranch_scc1 L_end
s_waitcnt vmcnt(1)
v_xor_b32 v124, v84, v176
v_xor_b32 v125, v86, v178
v_bitop3_b32 v124, v85, v177, v124 bitop3:0xbe
v_bitop3_b32 v125, v87, v179, v125 bitop3:0xbe
v_bitop3_b32 v124, v124, v125, v7 bitop3:0x54
v_cmp_ne_u32 s[40:41], 0, v124
s_waitcnt vmcnt(0)
v_xor_b32 v124, v88, v176
v_xor_b32 v125, v90, v178
v_bitop3_b32 v124, v89, v177, v124 bitop3:0xbe
v_bitop3_b32 v125, v91, v179, v125 bitop3:0xbe
v_bitop3_b32 v124, v124, v125, v7 bitop3:0x54
v_cmp_ne_u32 vcc, 0, v124
s_or_b64 vcc, vcc, s[40:41]
s_and_b64 exec, exec, vcc
s_cbranch_execnz L_qp0
s_mov_b64 exec, -1
v_and_b32 v84, v7, v84
v_and_b32 v85, v7, v85
v_and_b32 v86, v7, v86
v_and_b32 v87, v7, v87
v_and_b32 v88, v7, v88
v_and_b32 v89, v7, v89
v_and_b32 v90, v7, v90
v_and_b32 v91, v7, v91
v_add_f32 v84, v84, v88
v_add_f32 v85, v85, v89
v_add_f32 v86, v86, v90
v_add_f32 v87, v87, v91
s_nop 0
v_permlane32_swap_b32 v84, v86
v_permlane32_swap_b32 v85, v87
v_add_f32 v84, v84, v86
v_add_f32 v85, v85, v87
v_cvt_pk_bf16_f32 v84, v84, v85
v_mov_b32 v3, 1
ds_write_b32 v96, v84 offset:4096
s_mov_b64 exec, 15
ds_write_b32 v105, v3 offset:6752
s_mov_b64 exec, -1
L_qx0:
s_mov_b32 s28, s74
s_mov_b32 s29, s75
s_add_u32 m0, s39, 24576
s_mov_b32 s3, 0
buffer_load_dwordx4 v100, s[28:31], s3 offen nt lds
s_add_u32 m0, s39, 25600
s_mov_b32 s3, 65536
buffer_load_dwordx4 v100, s[28:31], s3 offen nt lds
s_add_u32 m0, s39, 26624
s_mov_b32 s3, 131072
buffer_load_dwordx4 v100, s[28:31], s3 offen nt lds
s_add_u32 m0, s39, 27648
s_mov_b32 s3, 196608
buffer_load_dwordx4 v100, s[28:31], s3 offen nt lds
s_mov_b32 s32, s68
s_mov_b32 s33, s69
buffer_load_dwordx4 v[24:27], v99, s[32:35], 0 offen offset:0
buffer_load_dwordx4 v[28:31], v99, s[32:35], 0 offen offset:64
buffer_load_dwordx4 v[32:35], v99, s[32:35], 0 offen offset:128
buffer_load_dwordx4 v[36:39], v99, s[32:35], 0 offen offset:192
v_add_u32 v94, 0x40000, v94
v_add_u32 v95, 0x40000, v95
s_waitcnt vmcnt(0)
v_mov_b32 v3, 2
s_mov_b64 exec, 1
ds_write_b32 v97, v3 offset:6736
s_mov_b64 exec, -1
s_mov_b32 s48, s20
s_mov_b32 s49, s21
s_mov_b32 s50, 0x2000
s_mov_b32 s51, 0x20000
s_movk_i32 s36, 0x1000
s_lshl_b32 s3, s5, 3
s_add_u32 s57, s3, s26
s_add_u32 s3, s3, s7
s_lshl_b32 s3, s3, 10
s_add_u32 s3, s3, 0x40000
v_lshl_add_u32 v104, v0, 4, s3
s_lshl_b32 s3, s57, 10
s_add_u32 s3, s3, 0x40000
v_lshl_add_u32 v103, v0, 4, s3
s_lshl_b32 s3, s57, 8
s_add_u32 s27, s3, 0x10000
v_mov_b32 v102, s27
v_lshrrev_b32 v2, 2, v5
v_lshlrev_b32 v2, 8, v2
v_lshl_add_u32 v106, v4, 4, v2
s_lshl_b32 s3, s57, 2
s_add_u32 s3, s3, s7
s_lshl_b32 s3, s3, 9
s_add_u32 s3, s3, 0x80000
v_lshl_add_u32 v107, v5, 4, s3
v_lshl_add_u32 v107, v4, 7, v107
s_lshl_b32 s3, s5, 2
s_add_u32 s3, s3, s4
s_lshl_b32 s3, s3, 1
s_add_u32 s3, s3, s6
s_lshl_b32 s3, s3, 6
s_add_u32 s3, s3, 0x80000
v_lshrrev_b32 v2, 2, v0
v_and_b32 v3, 3, v0
v_lshl_add_u32 v108, v3, 4, s3
v_lshl_add_u32 v108, v2, 14, v108
s_lshl_b32 s3, s4, 6
s_add_u32 s3, s3, s5
s_lshl_b32 s3, s3, 2
s_add_u32 s3, s3, s6
s_lshl_b32 s3, s3, 3
v_lshl_add_u32 v109, v3, 1, s3
v_and_b32 v3, 1, v2
v_lshl_add_u32 v109, v3, 10, v109
v_bfe_u32 v3, v0, 3, 1
v_lshl_add_u32 v109, v3, 4, v109
s_mov_b32 s38, 0x40000
s_mov_b32 s56, 0x400000
L_q1:
ds_read_b128 v[124:127], v98 offset:6736
s_sub_u32 s56, s56, 1
s_cbranch_scc1 L_end
s_waitcnt lgkmcnt(0)
v_min3_u32 v124, v124, v125, v126
v_min_u32 v124, v124, v127
s_nop 0
v_readfirstlane_b32 s3, v124
s_cmp_ge_u32 s3, 2
s_cbranch_scc0 L_q1
ds_read_b64_tr_b16 v[40:41], v92 offset:16384
ds_read_b64_tr_b16 v[42:43], v92 offset:16896
ds_read_b64_tr_b16 v[44:45], v92 offset:20480
ds_read_b64_tr_b16 v[46:47], v92 offset:20992
ds_read_b64_tr_b16 v[48:49], v92 offset:24576
ds_read_b64_tr_b16 v[50:51], v92 offset:25088
ds_read_b64_tr_b16 v[52:53], v92 offset:28672
ds_read_b64_tr_b16 v[54:55], v92 offset:29184
s_waitcnt lgkmcnt(6)
v_mfma_f32_16x16x32_bf16 v[72:75], v[24:27], v[40:43], 0
s_waitcnt lgkmcnt(4)
v_mfma_f32_16x16x32_bf16 v[72:75], v[28:31], v[44:47], v[72:75]
s_waitcnt lgkmcnt(2)
v_mfma_f32_16x16x32_bf16 v[72:75], v[32:35], v[48:51], v[72:75]
s_waitcnt lgkmcnt(0)
v_mfma_f32_16x16x32_bf16 v[72:75], v[36:39], v[52:55], v[72:75]
s_nop 7
v_mov_b32_dpp v81, v72 quad_perm:[1,1,1,1] row_mask:0xf bank_mask:0xf
v_mov_b32_dpp v82, v72 quad_perm:[2,2,2,2] row_mask:0xf bank_mask:0xf
v_mov_b32_dpp v83, v72 quad_perm:[3,3,3,3] row_mask:0xf bank_mask:0xf
v_add_u32 v80, 0x80, v72
v_and_or_b32 v80, v80, v7, v176
v_add_u32 v81, 0x80, v81
v_and_or_b32 v81, v81, v7, v177
v_add_u32 v82, 0x80, v82
v_and_or_b32 v82, v82, v7, v178
v_add_u32 v83, 0x80, v83
v_and_or_b32 v83, v83, v7, v179
s_mov_b32 exec_lo, 0x11111111
s_mov_b32 exec_hi, 0x11111111
buffer_store_dwordx4 v[80:83], v94, s[44:47], 0 offen sc1
s_mov_b64 exec, -1
s_cmp_lg_u32 s7, 0
s_cbranch_scc1 L_qx1
s_mov_b32 s56, 0x40000
L_sq1:
s_load_dword s64, s[62:63], 0x40300 glc
s_load_dword s65, s[62:63], 0x40700 glc
s_load_dword s66, s[62:63], 0x40b00 glc
s_load_dword s67, s[62:63], 0x40f00 glc
s_load_dword s78, s[62:63], 0x41300 glc
s_load_dword s79, s[62:63], 0x41700 glc
s_load_dword s42, s[62:63], 0x41b00 glc
s_load_dword s43, s[62:63], 0x41f00 glc
s_sub_u32 s56, s56, 1
s_cbranch_scc1 L_end
s_waitcnt lgkmcnt(0)
s_xor_b32 s64, s64, s37
s_xor_b32 s65, s65, s37
s_xor_b32 s66, s66, s37
s_xor_b32 s67, s67, s37
s_xor_b32 s78, s78, s37
s_xor_b32 s79, s79, s37
s_xor_b32 s42, s42, s37
s_xor_b32 s43, s43, s37
s_or_b32 s64, s64, s65
s_or_b32 s64, s64, s66
s_or_b32 s64, s64, s67
s_or_b32 s64, s64, s78
s_or_b32 s64, s64, s79
s_or_b32 s64, s64, s42
s_or_b32 s64, s64, s43
s_and_b32 s64, s64, 0xff
s_cbranch_scc1 L_sq1
s_mov_b32 s56, 0x40000
L_qp1:
buffer_load_dwordx4 v[84:87], v95, s[44:47], 0 offen sc1
buffer_load_dwordx4 v[88:91], v95, s[44:47], 0 offen offset:2048 sc1
s_sub_u32 s56, s56, 1
s_cbranch_scc1 L_end
s_waitcnt vmcnt(1)
v_xor_b32 v124, v84, v176
v_xor_b32 v125, v86, v178
v_bitop3_b32 v124, v85, v177, v124 bitop3:0xbe
v_bitop3_b32 v125, v87, v179, v125 bitop3:0xbe
v_bitop3_b32 v124, v124, v125, v7 bitop3:0x54
v_cmp_ne_u32 s[40:41], 0, v124
s_waitcnt vmcnt(0)
v_xor_b32 v124, v88, v176
v_xor_b32 v125, v90, v178
v_bitop3_b32 v124, v89, v177, v124 bitop3:0xbe
v_bitop3_b32 v125, v91, v179, v125 bitop3:0xbe
v_bitop3_b32 v124, v124, v125, v7 bitop3:0x54
v_cmp_ne_u32 vcc, 0, v124
s_or_b64 vcc, vcc, s[40:41]
s_and_b64 exec, exec, vcc
s_cbranch_execnz L_qp1
s_mov_b64 exec, -1
v_and_b32 v84, v7, v84
v_and_b32 v85, v7, v85
v_and_b32 v86, v7, v86
v_and_b32 v87, v7, v87
v_and_b32 v88, v7, v88
v_and_b32 v89, v7, v89
v_and_b32 v90, v7, v90
v_and_b32 v91, v7, v91
v_add_f32 v84, v84, v88
v_add_f32 v85, v85, v89
v_add_f32 v86, v86, v90
v_add_f32 v87, v87, v91
s_nop 0
v_permlane32_swap_b32 v84, v86
v_permlane32_swap_b32 v85, v87
v_add_f32 v84, v84, v86
v_add_f32 v85, v85, v87
v_cvt_pk_bf16_f32 v84, v84, v85
v_mov_b32 v3, 2
ds_write_b32 v96, v84 offset:4352
s_mov_b64 exec, 15
ds_write_b32 v105, v3 offset:6752
s_mov_b64 exec, -1
L_qx1:
s_and_b32 s3, s37, 0x3ff
v_mov_b32 v176, s3
v_mov_b32 v7, 0xfffffc00
v_xor_b32 v177, 0x3ff, v176
v_xor_b32 v178, 0x155, v176
v_xor_b32 v179, 0x2aa, v176
s_mov_b32 exec_lo, 0xff00ff
s_mov_b32 exec_hi, 0xff00ff
buffer_load_dword v200, v107, s[44:47], 0 offen sc1
s_mov_b64 exec, -1
s_and_b32 s3, s2, 7
s_lshl_b32 s3, s3, 8
s_add_u32 s3, s3, 0x1000
v_lshl_add_u32 v88, v0, 2, s3
s_lshr_b32 s8, s2, 3
s_lshl_b32 s9, s8, 2
s_add_u32 s12, s3, s9
s_lshl_b32 s9, s37, 10
s_lshr_b32 s10, s9, 10
s_mov_b32 s56, 0x40000
s_cmp_lg_u32 s7, 1
s_cbranch_scc1 L_fby
v_mov_b32 v89, s12
L_fb:
s_sleep 16
ds_read_b32 v84, v98 offset:6768
s_sub_u32 s56, s56, 1
s_cbranch_scc1 L_fbx
s_waitcnt lgkmcnt(0)
v_readfirstlane_b32 s11, v84
v_or_b32 v84, s9, v84
s_mov_b64 exec, 1
buffer_store_dword v84, v89, s[44:47], 0 offen
s_mov_b32 exec_lo, 0xffffffff
s_mov_b32 exec_hi, 0x0
buffer_load_dword v85, v88, s[44:47], 0 offen sc1
s_waitcnt vmcnt(0)
v_add_u32 v86, 0, v84
v_lshrrev_b32 v87, 10, v85
v_cmp_eq_u32 vcc, s10, v87
v_cmp_ge_u32 s[40:41], v85, v86
s_and_b64 vcc, vcc, s[40:41]
s_bcnt1_i32_b64 s3, vcc
s_cmp_ge_u32 s3, 16
s_cselect_b32 s3, 1, 0
v_mov_b32 v84, s3
s_mov_b64 exec, 1
ds_write_b32 v98, v84 offset:6772
s_mov_b64 exec, -1
s_cmp_lt_u32 s11, 448
s_cbranch_scc1 L_fb
s_branch L_fbx
L_fby:
L_fbx:
s_cmp_lg_u32 s7, 0
s_cbranch_scc1 L_h2
buffer_load_dword v201, v103, s[44:47], 0 offen sc1
buffer_load_dword v202, v102, s[44:47], 0 offen sc1
s_mov_b32 s56, 0x40000
L_w1:
ds_read_b128 v[124:127], v98 offset:6720
s_sub_u32 s56, s56, 1
s_cbranch_scc1 L_end
s_waitcnt lgkmcnt(0)
v_min3_u32 v124, v124, v125, v126
v_min_u32 v124, v124, v127
s_nop 0
v_readfirstlane_b32 s3, v124
s_cmp_ge_u32 s3, 3
s_cbranch_scc1 L_w1x
s_sleep 16
s_branch L_w1
L_w1x:
ds_read_b128 v[116:119], v98 offset:6656
ds_read_b128 v[120:123], v98 offset:6672
s_waitcnt lgkmcnt(0)
v_max3_f32 v72, v116, v118, v120
v_max_f32 v72, v72, v122
v_and_b32 v72, v7, v72
v_sub_f32 v124, v116, v72
v_sub_f32 v125, v118, v72
v_sub_f32 v126, v120, v72
v_sub_f32 v127, v122, v72
v_exp_f32 v124, v124
v_exp_f32 v125, v125
v_exp_f32 v126, v126
v_exp_f32 v127, v127
s_nop 0
v_mul_f32 v73, v124, v117
v_fma_f32 v73, v125, v119, v73
v_fma_f32 v73, v126, v121, v73
v_fma_f32 v73, v127, v123, v73
v_and_b32 v73, v7, v73
ds_read_b64 v[128:129], v110 offset:0
ds_read_b64 v[130:131], v110 offset:512
ds_read_b64 v[132:133], v110 offset:1024
ds_read_b64 v[134:135], v110 offset:1536
s_waitcnt lgkmcnt(3)
v_mul_f32 v140, v124, v128
v_mul_f32 v141, v124, v129
s_waitcnt lgkmcnt(2)
v_fma_f32 v140, v125, v130, v140
v_fma_f32 v141, v125, v131, v141
s_waitcnt lgkmcnt(1)
v_fma_f32 v140, v126, v132, v140
v_fma_f32 v141, v126, v133, v141
s_waitcnt lgkmcnt(0)
v_fma_f32 v140, v127, v134, v140
v_fma_f32 v141, v127, v135, v141
s_mov_b32 s56, 0x40000
L_w2:
ds_read_b128 v[124:127], v98 offset:6720
s_sub_u32 s56, s56, 1
s_cbranch_scc1 L_end
s_waitcnt lgkmcnt(0)
v_min3_u32 v124, v124, v125, v126
v_min_u32 v124, v124, v127
s_nop 0
v_readfirstlane_b32 s3, v124
s_cmp_ge_u32 s3, 4
s_cbranch_scc1 L_w2x
s_sleep 16
s_branch L_w2
L_w2x:
ds_read_b128 v[116:119], v98 offset:6688
ds_read_b128 v[120:123], v98 offset:6704
s_waitcnt lgkmcnt(0)
v_max3_f32 v74, v116, v118, v120
v_max_f32 v74, v74, v122
v_and_b32 v74, v7, v74
v_sub_f32 v124, v116, v74
v_sub_f32 v125, v118, v74
v_sub_f32 v126, v120, v74
v_sub_f32 v127, v122, v74
v_exp_f32 v124, v124
v_exp_f32 v125, v125
v_exp_f32 v126, v126
v_exp_f32 v127, v127
s_nop 0
v_mul_f32 v75, v124, v117
v_fma_f32 v75, v125, v119, v75
v_fma_f32 v75, v126, v121, v75
v_fma_f32 v75, v127, v123, v75
v_and_b32 v75, v7, v75
v_and_or_b32 v80, v72, v7, v176
v_and_or_b32 v81, v73, v7, v177
v_and_or_b32 v82, v74, v7, v178
v_and_or_b32 v83, v75, v7, v179
s_xor_b32 s3, s27, 0x400
s_add_u32 s16, s24, s3
s_addc_u32 s17, s25, 0
s_mov_b32 s56, 0x40000
s_getreg_b32 s3, hwreg(HW_REG_XCC_ID, 0, 4)
s_lshl_b32 s27, s3, 10
s_mov_b64 exec, 2
v_or_b32 v80, s27, v176
v_or_b32 v81, s27, v177
v_or_b32 v82, s27, v178
v_or_b32 v83, s27, v179
v_add_u32 v102, 16, v102
s_mov_b64 exec, 3
buffer_store_dwordx4 v[80:83], v102, s[44:47], 0 offen sc1
s_mov_b64 exec, -1
L_ml:
s_load_dwordx4 s[8:11], s[16:17], 0 glc
s_sub_u32 s56, s56, 1
s_cbranch_scc1 L_end
s_waitcnt lgkmcnt(0)
s_xor_b32 s12, s8, s37
s_xor_b32 s13, s9, s37
s_xor_b32 s13, s13, 0x3ff
s_xor_b32 s14, s10, s37
s_xor_b32 s14, s14, 0x155
s_xor_b32 s15, s11, s37
s_xor_b32 s15, s15, 0x2aa
s_or_b32 s12, s12, s13
s_or_b32 s14, s14, s15
s_or_b32 s12, s12, s14
s_and_b32 s12, s12, 0x3ff
s_cbranch_scc1 L_ml
v_and_b32 v84, s8, v7
v_and_b32 v85, s9, v7
v_and_b32 v86, s10, v7
v_and_b32 v87, s11, v7
v_max_f32 v3, v72, v84
v_sub_f32 v124, v72, v3
v_sub_f32 v125, v84, v3
v_exp_f32 v124, v124
v_exp_f32 v125, v125
s_nop 0
v_mul_f32 v2, v124, v73
v_fma_f32 v2, v125, v85, v2
v_rcp_f32 v2, v2
v_max_f32 v3, v74, v86
v_mul_f32 v2, v2, v124
v_mul_f32 v140, v140, v2
v_mul_f32 v141, v141, v2
v_add_u32 v80, 0x200, v140
v_and_or_b32 v80, v80, v7, v176
v_add_u32 v81, 0x200, v141
v_and_or_b32 v81, v81, v7, v177
v_sub_f32 v124, v74, v3
v_sub_f32 v125, v86, v3
v_exp_f32 v124, v124
v_exp_f32 v125, v125
s_nop 0
v_mul_f32 v2, v124, v75
v_fma_f32 v2, v125, v87, v2
v_rcp_f32 v2, v2
v_sub_f32 v116, v116, v3
v_sub_f32 v118, v118, v3
v_sub_f32 v120, v120, v3
v_sub_f32 v122, v122, v3
v_exp_f32 v116, v116
v_exp_f32 v118, v118
v_exp_f32 v120, v120
v_exp_f32 v122, v122
s_nop 0
v_mul_f32 v116, v116, v2
v_mul_f32 v118, v118, v2
v_mul_f32 v120, v120, v2
v_mul_f32 v122, v122, v2
s_mov_b32 s56, 0x40000
L_wx:
s_sleep 16
ds_read_b32 v124, v98 offset:6768
s_sub_u32 s56, s56, 1
s_cbranch_scc1 L_end
s_waitcnt lgkmcnt(0)
v_readfirstlane_b32 s3, v124
s_cmp_ge_u32 s3, 416
s_cbranch_scc0 L_wx
s_cmp_lg_u32 s7, 0
s_cbranch_scc1 L_x1
s_lshl_b32 s3, s5, 11
s_add_u32 s3, s3, 0x10010
v_lshl_add_u32 v2, v0, 8, s3
s_mov_b32 exec_lo, 0xff
s_mov_b32 exec_hi, 0x0
buffer_load_dwordx4 v[84:87], v2, s[44:47], 0 offen sc1
s_waitcnt vmcnt(0)
v_xor_b32 v84, v84, v176
v_xor_b32 v85, v85, v177
v_xor_b32 v86, v86, v178
v_xor_b32 v87, v87, v179
v_bitop3_b32 v124, v84, v85, s27 bitop3:0x7e
v_bitop3_b32 v125, v86, v87, s27 bitop3:0x7e
v_or_b32 v124, v124, v125
v_cmp_ne_u32 s[42:43], 0, v124
s_mov_b64 exec, -1
L_x1:
L_h2:
s_mov_b32 s56, 0x40000
L_w3:
ds_read_b128 v[124:127], v98 offset:6720
s_sub_u32 s56, s56, 1
s_cbranch_scc1 L_end
s_waitcnt lgkmcnt(0)
v_min3_u32 v124, v124, v125, v126
v_min_u32 v124, v124, v127
s_nop 0
v_readfirstlane_b32 s3, v124
s_cmp_ge_u32 s3, 5
s_cbranch_scc1 L_w3x
s_sleep 16
s_branch L_w3
L_w3x:
s_mov_b32 s56, 0x400000
L_wp:
ds_read_b32 v124, v98 offset:6768
s_sub_u32 s56, s56, 1
s_cbranch_scc1 L_end
s_waitcnt lgkmcnt(0)
v_readfirstlane_b32 s3, v124
s_cmp_ge_u32 s3, 508
s_cbranch_scc0 L_wp
s_mov_b32 s28, s52
s_mov_b32 s29, s53
s_add_u32 m0, s39, 40960
s_mov_b32 s3, 0
buffer_load_dwordx4 v101, s[28:31], s3 offen nt lds
s_add_u32 m0, s39, 41984
s_mov_b32 s3, 8192
buffer_load_dwordx4 v101, s[28:31], s3 offen nt lds
s_add_u32 m0, s39, 43008
s_mov_b32 s3, 16384
buffer_load_dwordx4 v101, s[28:31], s3 offen nt lds
s_add_u32 m0, s39, 44032
s_mov_b32 s3, 24576
buffer_load_dwordx4 v101, s[28:31], s3 offen nt lds
s_mov_b32 s28, s76
s_mov_b32 s29, s77
s_add_u32 m0, s39, 57344
s_mov_b32 s3, 0
buffer_load_dwordx4 v101, s[28:31], s3 offen nt lds
s_add_u32 m0, s39, 58368
s_mov_b32 s3, 8192
buffer_load_dwordx4 v101, s[28:31], s3 offen nt lds
s_add_u32 m0, s39, 59392
s_mov_b32 s3, 16384
buffer_load_dwordx4 v101, s[28:31], s3 offen nt lds
s_add_u32 m0, s39, 60416
s_mov_b32 s3, 24576
buffer_load_dwordx4 v101, s[28:31], s3 offen nt lds
s_mov_b32 s56, 0x400000
L_w4:
ds_read_b128 v[124:127], v98 offset:6720
ds_read_b64 v[128:129], v110 offset:2048
ds_read_b64 v[130:131], v110 offset:2560
ds_read_b64 v[132:133], v110 offset:3072
ds_read_b64 v[134:135], v110 offset:3584
s_sub_u32 s56, s56, 1
s_cbranch_scc1 L_end
s_waitcnt lgkmcnt(4)
v_min3_u32 v124, v124, v125, v126
v_min_u32 v124, v124, v127
s_nop 0
v_readfirstlane_b32 s3, v124
s_cmp_ge_u32 s3, 6
s_cbranch_scc0 L_w4
s_cmp_lg_u32 s7, 0
s_cbranch_scc1 L_h4
s_waitcnt lgkmcnt(3)
v_mul_f32 v140, v116, v128
v_mul_f32 v141, v116, v129
s_waitcnt lgkmcnt(2)
v_fma_f32 v140, v118, v130, v140
v_fma_f32 v141, v118, v131, v141
s_waitcnt lgkmcnt(1)
v_fma_f32 v140, v120, v132, v140
v_fma_f32 v141, v120, v133, v141
s_waitcnt lgkmcnt(0)
v_fma_f32 v140, v122, v134, v140
v_fma_f32 v141, v122, v135, v141
v_add_u32 v82, 0x200, v140
v_and_or_b32 v82, v82, v7, v178
v_add_u32 v83, 0x200, v141
v_and_or_b32 v83, v83, v7, v179
s_cmp_eq_u64 s[42:43], 0
s_cbranch_scc1 L_x2
buffer_store_dwordx4 v[80:83], v103, s[44:47], 0 offen sc1
s_branch L_x3
L_x2:
buffer_store_dwordx4 v[80:83], v103, s[44:47], 0 offen
L_x3:
L_h4:
s_mov_b32 s56, 0x40000
L_op:
buffer_load_dwordx4 v[84:87], v104, s[44:47], 0 offen sc1
buffer_load_dwordx4 v[88:91], v104, s[44:47], s36 offen sc1
s_sub_u32 s56, s56, 1
s_cbranch_scc1 L_end
s_waitcnt vmcnt(1)
v_xor_b32 v124, v84, v176
v_xor_b32 v125, v86, v178
v_bitop3_b32 v124, v85, v177, v124 bitop3:0xbe
v_bitop3_b32 v125, v87, v179, v125 bitop3:0xbe
v_bitop3_b32 v124, v124, v125, v7 bitop3:0x54
v_cmp_ne_u32 s[40:41], 0, v124
s_waitcnt vmcnt(0)
v_xor_b32 v124, v88, v176
v_xor_b32 v125, v90, v178
v_bitop3_b32 v124, v89, v177, v124 bitop3:0xbe
v_bitop3_b32 v125, v91, v179, v125 bitop3:0xbe
v_bitop3_b32 v124, v124, v125, v7 bitop3:0x54
v_cmp_ne_u32 vcc, 0, v124
s_or_b64 vcc, vcc, s[40:41]
s_and_b64 exec, exec, vcc
s_cbranch_execnz L_op
s_mov_b64 exec, -1
v_and_b32 v84, v7, v84
v_and_b32 v85, v7, v85
v_and_b32 v86, v7, v86
v_and_b32 v87, v7, v87
v_and_b32 v88, v7, v88
v_and_b32 v89, v7, v89
v_and_b32 v90, v7, v90
v_and_b32 v91, v7, v91
v_add_f32 v84, v84, v88
v_add_f32 v85, v85, v89
v_add_f32 v86, v86, v90
v_add_f32 v87, v87, v91
v_cvt_pk_bf16_f32 v84, v84, v85
v_cvt_pk_bf16_f32 v86, v86, v87
ds_write2st64_b32 v105, v84, v86 offset0:18 offset1:22
v_mov_b32 v3, 3
s_mov_b64 exec, 1
ds_write_b32 v97, v3 offset:6736
s_mov_b64 exec, -1
s_mov_b32 s56, 0x400000
L_w5:
ds_read_b128 v[124:127], v98 offset:6736
ds_read_b128 v[8:11], v106 offset:4608
ds_read_b128 v[12:15], v106 offset:4672
ds_read_b128 v[16:19], v106 offset:4736
ds_read_b128 v[20:23], v106 offset:4800
s_sub_u32 s56, s56, 1
s_cbranch_scc1 L_end
s_waitcnt lgkmcnt(4)
v_min3_u32 v124, v124, v125, v126
v_min_u32 v124, v124, v127
s_nop 0
v_readfirstlane_b32 s3, v124
s_cmp_ge_u32 s3, 3
s_cbranch_scc0 L_w5
ds_read_b64_tr_b16 v[40:41], v93 offset:0
ds_read_b64_tr_b16 v[42:43], v93 offset:512
ds_read_b64_tr_b16 v[44:45], v93 offset:4096
ds_read_b64_tr_b16 v[46:47], v93 offset:4608
ds_read_b64_tr_b16 v[48:49], v93 offset:8192
ds_read_b64_tr_b16 v[50:51], v93 offset:8704
ds_read_b64_tr_b16 v[52:53], v93 offset:12288
ds_read_b64_tr_b16 v[54:55], v93 offset:12800
ds_read_b128 v[24:27], v106 offset:5632
ds_read_b128 v[28:31], v106 offset:5696
ds_read_b128 v[32:35], v106 offset:5760
s_waitcnt lgkmcnt(9)
v_mfma_f32_16x16x32_bf16 v[72:75], v[8:11], v[40:43], 0
ds_read_b128 v[36:39], v106 offset:5824
ds_read_b64_tr_b16 v[56:57], v93 offset:16384
ds_read_b64_tr_b16 v[58:59], v93 offset:16896
ds_read_b64_tr_b16 v[60:61], v93 offset:20480
ds_read_b64_tr_b16 v[62:63], v93 offset:20992
ds_read_b64_tr_b16 v[64:65], v93 offset:24576
s_waitcnt lgkmcnt(13)
v_mfma_f32_16x16x32_bf16 v[72:75], v[12:15], v[44:47], v[72:75]
ds_read_b64_tr_b16 v[66:67], v93 offset:25088
ds_read_b64_tr_b16 v[68:69], v93 offset:28672
s_waitcnt lgkmcnt(13)
v_mfma_f32_16x16x32_bf16 v[72:75], v[16:19], v[48:51], v[72:75]
ds_read_b64_tr_b16 v[70:71], v93 offset:29184
s_waitcnt lgkmcnt(12)
v_mfma_f32_16x16x32_bf16 v[72:75], v[20:23], v[52:55], v[72:75]
s_waitcnt lgkmcnt(6)
v_mfma_f32_16x16x32_bf16 v[76:79], v[24:27], v[56:59], 0
s_waitcnt lgkmcnt(4)
v_mfma_f32_16x16x32_bf16 v[76:79], v[28:31], v[60:63], v[76:79]
s_waitcnt lgkmcnt(2)
v_mfma_f32_16x16x32_bf16 v[76:79], v[32:35], v[64:67], v[76:79]
s_waitcnt lgkmcnt(0)
v_mfma_f32_16x16x32_bf16 v[76:79], v[36:39], v[68:71], v[76:79]
s_nop 3
v_mov_b32_dpp v124, v72 row_ror:8 row_mask:0xf bank_mask:0xf
v_add_u32 v80, 0x200, v72
v_and_or_b32 v80, v80, v7, v176
s_nop 1
v_mov_b32_dpp v125, v76 row_ror:8 row_mask:0xf bank_mask:0xf
v_add_u32 v81, 0x200, v124
v_and_or_b32 v81, v81, v7, v177
v_add_u32 v82, 0x200, v76
v_and_or_b32 v82, v82, v7, v178
v_add_u32 v83, 0x200, v125
v_and_or_b32 v83, v83, v7, v179
s_mov_b32 exec_lo, 0xff00ff
s_mov_b32 exec_hi, 0xff00ff
buffer_store_dwordx4 v[80:83], v107, s[44:47], 0 offen sc1
s_mov_b64 exec, -1
s_cmp_lg_u32 s7, 0
s_cbranch_scc1 L_end
s_mov_b32 s56, 0x40000
L_poll:
buffer_load_dwordx4 v[84:87], v108, s[44:47], 0 offen sc1
buffer_load_dwordx4 v[88:91], v108, s[44:47], s38 offen sc1
s_sub_u32 s56, s56, 1
s_cbranch_scc1 L_end
s_waitcnt vmcnt(1)
v_xor_b32 v124, v84, v176
v_xor_b32 v125, v86, v178
v_bitop3_b32 v124, v85, v177, v124 bitop3:0xbe
v_bitop3_b32 v125, v87, v179, v125 bitop3:0xbe
v_bitop3_b32 v124, v124, v125, v7 bitop3:0x54
v_cmp_ne_u32 s[40:41], 0, v124
s_waitcnt vmcnt(0)
v_xor_b32 v124, v88, v176
v_xor_b32 v125, v90, v178
v_bitop3_b32 v124, v89, v177, v124 bitop3:0xbe
v_bitop3_b32 v125, v91, v179, v125 bitop3:0xbe
v_bitop3_b32 v124, v124, v125, v7 bitop3:0x54
v_cmp_ne_u32 vcc, 0, v124
s_or_b64 vcc, vcc, s[40:41]
s_and_b64 exec, exec, vcc
s_cbranch_execnz L_poll
s_mov_b64 exec, -1
v_and_b32 v84, v7, v84
v_and_b32 v85, v7, v85
v_and_b32 v86, v7, v86
v_and_b32 v87, v7, v87
v_and_b32 v88, v7, v88
v_and_b32 v89, v7, v89
v_and_b32 v90, v7, v90
v_and_b32 v91, v7, v91
v_add_f32 v84, v84, v88
v_add_f32 v85, v85, v89
v_add_f32 v86, v86, v90
v_add_f32 v87, v87, v91
s_nop 0
v_add_f32_dpp v124, v84, v84 row_ror:8 row_mask:0xf bank_mask:0x3
v_add_f32_dpp v125, v86, v86 row_ror:8 row_mask:0xf bank_mask:0x3
v_add_f32_dpp v124, v85, v85 row_ror:8 row_mask:0xf bank_mask:0xc
v_add_f32_dpp v125, v87, v87 row_ror:8 row_mask:0xf bank_mask:0xc
s_nop 0
v_add_f32_dpp v84, v124, v124 row_shl:4 row_mask:0xf bank_mask:0x5
v_add_f32_dpp v84, v125, v125 row_shr:4 row_mask:0xf bank_mask:0xa
v_mov_b32 v3, v84
s_nop 1
v_permlane32_swap_b32 v84, v3
v_add_f32 v84, v84, v3
v_mov_b32 v3, v84
s_nop 1
v_permlane16_swap_b32 v84, v3
v_add_f32 v84, v84, v3
v_cvt_pk_bf16_f32 v84, v84, v84
s_mov_b32 exec_lo, 0xffff
s_mov_b32 exec_hi, 0x0
buffer_store_short v84, v109, s[48:51], 0 offen
s_cmp_lg_u32 s2, 0
s_cbranch_scc1 L_fin
s_mov_b64 exec, 1
buffer_store_dword v112, v98, s[44:47], 0 offen sc1
L_fin:
L_end:
s_endpgm
.section .rodata,"a"
.p2align 6
.amdhsa_kernel concat_heads__mha_block_cached__mha_block_cached__decode_kernel
  .amdhsa_next_free_vgpr 256
  .amdhsa_next_free_sgpr 102
  .amdhsa_accum_offset 256
  .amdhsa_group_segment_fixed_size 0
  .amdhsa_kernarg_size 104
  .amdhsa_user_sgpr_count 2
  .amdhsa_user_sgpr_kernarg_segment_ptr 1
  .amdhsa_system_sgpr_workgroup_id_x 1
.end_amdhsa_kernel
```
